```python
import torch

def _softmax(x, axis=-1):
    return torch.softmax(x, dim=axis)
def _gelu(x):
    return torch.nn.functional.gelu(x, approximate="tanh")
def _silu(x):
    return torch.nn.functional.silu(x)
def _sigmoid(x):
    return torch.sigmoid(x)
def _layernorm(x, axis=-1, eps=1e-5):
    m = x.mean(dim=axis, keepdim=True)
    v = x.var(dim=axis, keepdim=True, unbiased=False)
    return (x - m) / torch.sqrt(v + eps)
def _scatter_add(tgt, idx, src, axis=0):
    return tgt.clone().index_add_(axis, idx, src)
def _segment_sum(src, seg, n):
    out = torch.zeros((n,) + src.shape[1:], dtype=src.dtype)
    return out.index_add_(0, seg, src)
def _pad(x, pw):
    flat = tuple(v for pair in reversed(pw) for v in pair)
    return torch.nn.functional.pad(x, flat)

kernel_name = 'concat_heads__sliding_local_dilated__sliding_block__prompt'

def setup_inputs():

    _w = (lambda a: (lambda t: t.to(torch.bfloat16) if t.is_floating_point() else t)(torch.as_tensor(a)))
    def _A_setup():
        B, S, D = 1, 2048, 640
        return {
            "x": _w((lambda *s: torch.randn(*s, dtype=torch.bfloat16) * 0.2)(B, S, D)),
            "wqkv": _w((lambda *s: torch.randn(*s, dtype=torch.bfloat16) * 0.2)(D, 3 * D)),
            "wo": _w((lambda *s: torch.randn(*s, dtype=torch.bfloat16) * 0.05)(D, D)),
        }
    _A_in = _A_setup()

    def _B_setup():
        B, S, D = 1, 2048, 640
        return {
            "x": _w((lambda *s: torch.randn(*s, dtype=torch.bfloat16) * 0.2)(B, S, D)),
            "wqkv": _w((lambda *s: torch.randn(*s, dtype=torch.bfloat16) * 0.2)(D, 3 * D)),
            "wo": _w((lambda *s: torch.randn(*s, dtype=torch.bfloat16) * 0.05)(D, D)),
        }
    _B_in = _B_setup()

    return {
        "A_x": _A_in["x"],
        "A_wqkv": _A_in["wqkv"],
        "A_wo": _A_in["wo"],
        "B_x": _B_in["x"],
        "B_wqkv": _B_in["wqkv"],
        "B_wo": _B_in["wo"],
    }

def reference(A_x, A_wqkv, A_wo, B_x, B_wqkv, B_wo):
    def _A_ref(x, wqkv, wo):
        B, S, D = x.shape
        H = 32; Dh = D // H
        W, dil = 8, 2
        qkv = (lambda x, *d: x.permute(*d))((x @ wqkv).reshape(B, S, 3, H, Dh), 2, 0, 3, 1, 4)
        q, k, v = qkv[0], qkv[1], qkv[2]
        scale = Dh ** -0.5
        pos = torch.arange(S)
        off = torch.arange(W) * dil
        idx = pos[:, None] - off[None, :]
        mask = idx >= 0
        idx_c = torch.where(mask, idx, 0).reshape(-1)
        kg = k[:, :, idx_c, :].reshape(B, H, S, W, Dh)
        vg = v[:, :, idx_c, :].reshape(B, H, S, W, Dh)
        logits = torch.einsum("bhsd,bhswd->bhsw", q, kg) * scale
        logits = torch.where(mask[None, None, :, :], logits, -1e9)
        attn = _softmax(logits, axis=-1)
        o = torch.einsum("bhsw,bhswd->bhsd", attn, vg)
        return (lambda x, *d: x.permute(*d))(o, 0, 2, 1, 3).reshape(B, S, D) @ wo

    def _B_ref(x, wqkv, wo):
        B, S, D = x.shape
        H = 32; Dh = D // H; W = 256
        qkv = (lambda x, *d: x.permute(*d))((x @ wqkv).reshape(B, S, 3, H, Dh), 2, 0, 3, 1, 4)
        q, k, v = qkv[0], qkv[1], qkv[2]
        scores = torch.einsum("bhqd,bhkd->bhqk", q, k) * (Dh ** -0.5)
        idx = torch.arange(S)
        mask = (idx[:, None] - idx[None, :] >= 0) & (idx[:, None] - idx[None, :] < W)
        scores = torch.where(mask[None, None], scores, -1e9)
        p = _softmax(scores, axis=-1)
        o = torch.einsum("bhqk,bhkd->bhqd", p, v)
        return (lambda x, *d: x.permute(*d))(o, 0, 2, 1, 3).reshape(B, S, D) @ wo

    a = _A_ref(A_x, A_wqkv, A_wo)
    b = _B_ref(B_x, B_wqkv, B_wo)
    return torch.concatenate([a, b], axis=-1)
```

```asm
; @launch grid=(256,1,1) block=(512,1,1) lds=163840
.amdgcn_target "amdgcn-amd-amdhsa--gfx950"
.text
.globl concat_heads__sliding_local_dilated__sliding_block__prompt_kernel
.p2align 8
.type concat_heads__sliding_local_dilated__sliding_block__prompt_kernel,@function
concat_heads__sliding_local_dilated__sliding_block__prompt_kernel:
    s_cmp_ge_u32 s2, 256
    s_cbranch_scc1 L_end
    s_load_dwordx16 s[64:79], s[0:1], 0
    s_load_dwordx2 s[80:81], s[0:1], 64
    v_lshrrev_b32 v2, 6, v0
    v_and_b32 v1, 63, v0
    v_readfirstlane_b32 s31, v2
    s_lshr_b32 s34, s2, 3
    s_lshr_b32 s28, s2, 7
    s_and_b32 s33, s2, 3
    s_lshl_b32 s33, s33, 1
    s_bfe_u32 s35, s2, 0x10006
    s_add_u32 s29, s33, s35
    s_and_b32 s30, s34, 7
    s_bfe_u32 s35, s2, 0x10002
    s_lshl_b32 s35, s35, 3
    s_add_u32 s30, s30, s35
    s_and_b32 s34, s34, 15
    s_lshl_b32 s33, s28, 3
    s_add_u32 s33, s33, s29
    s_lshl_b32 s33, s33, 4
    s_add_u32 s32, s33, s30
    s_xor_b32 s92, s28, 1
    s_mul_i32 s92, s92, 0
    s_mov_b32 s6, 2621440
    s_mov_b32 s7, 0x20000
    s_mov_b32 s10, 2457600
    s_mov_b32 s11, 0x20000
    s_mov_b32 s14, 819200
    s_mov_b32 s15, 0x20000
    s_mov_b32 s18, 5242880
    s_mov_b32 s19, 0x20000
    s_mov_b32 s26, 256
    s_mov_b32 s27, 0x20000
    s_mov_b32 s22, 0x10000000
    s_mov_b32 s23, 0x20000
    s_cmp_lt_u32 s31, 4
    s_cbranch_scc1 L_compute
    s_sub_u32 s50, s31, 4
    s_and_b32 s33, s30, 7
    s_lshr_b32 s57, 0xa5, s33
    s_and_b32 s57, s57, 1
    s_lshr_b32 s33, s34, 1
    s_lshl_b32 s33, s33, 2
    s_add_u32 s33, s33, s50
    s_lshl_b32 s35, s34, 2
    s_add_u32 s35, s35, s50
    s_mul_i32 s60, s35, 12800
    s_and_b32 s99, s2, 3
    s_lshl_b32 s99, s99, 6
    s_add_u32 s99, s99, s35
    s_mul_i32 s99, s99, 10240
    s_bfe_u32 s37, s2, 0x10002
    s_mul_i32 s37, s37, 640
    s_add_u32 s60, s60, s37
    s_mul_i32 s35, s33, 7680
    s_add_u32 s35, s35, s37
    s_and_b32 s36, s2, 3
    s_lshl_b32 s36, s36, 5
    s_add_u32 s36, s36, s33
    s_mul_i32 s36, s36, 20480
    v_mul_u32_u24 v10, 2185, v1
    v_lshrrev_b32 v10, 16, v10
    v_mul_u32_u24 v10, 238080, v10
    v_mul_u32_u24 v12, 13108, v1
    v_lshrrev_b32 v12, 16, v12
    v_mul_u32_u24 v12, 640, v12
    v_lshl_add_u32 v16, v1, 7, v12
    v_add_u32 v10, v10, v16
    v_and_b32 v11, 15, v1
    v_mul_u32_u24 v11, 1280, v11
    v_lshrrev_b32 v12, 4, v1
    v_lshl_add_u32 v11, v12, 7, v11
    s_cmp_eq_u32 s57, 1
    s_cselect_b32 s58, s35, s36
    s_cselect_b32 s59, 491520, 0
    s_cselect_b32 s88, -1, -1
    s_cselect_b32 s89, 0xfffffff, 0
    s_cselect_b32 s90, 1, -1
    s_cselect_b32 s91, 0, 0x3ffff
    s_cselect_b64 vcc, -1, 0
    s_max_u32 s59, s59, 256
    v_cndmask_b32 v15, v11, v10, vcc
    v_cndmask_b32 v17, v10, v11, vcc
    s_cmp_eq_u32 s57, 1
    s_cselect_b32 s63, s36, s35
    s_cselect_b32 s56, 0, 491520
    s_cselect_b32 s91, 0, 0xfffffff
    s_max_u32 s56, s56, 256
    s_mov_b32 s53, s58
    s_mov_b32 s54, s59
    s_mov_b32 s55, s89
    s_cmp_eq_u32 s28, 0
    s_cselect_b32 s63, s63, 0
    s_cselect_b32 s56, s56, 0
    s_cselect_b32 s91, s91, 0
    s_cselect_b32 s90, -1, 1
    s_lshl_b32 s33, s29, 8
    s_lshl_b32 s34, s50, 6
    s_add_u32 s33, s33, s34
    s_mul_i32 s33, s33, 1280
    v_lshrrev_b32 v10, 3, v1
    v_mul_u32_u24 v10, 1280, v10
    v_add_u32 v10, s33, v10
    v_and_b32 v11, 7, v1
    v_lshrrev_b32 v12, 4, v1
    v_xor_b32 v11, v11, v12
    v_lshl_add_u32 v2, v11, 4, v10
    v_xor_b32 v11, 4, v11
    v_lshl_add_u32 v3, v11, 4, v10
    v_add_u32 v3, 9216, v3
    v_add_u32 v4, 18432, v2
    v_add_u32 v5, 18432, v3
    v_bfe_u32 v11, v1, 1, 3
    v_xor_b32 v11, v11, v12
    s_mul_i32 s34, s50, 61440
    s_mul_i32 s35, s30, 80
    s_add_u32 s34, s34, s35
    v_mul_u32_u24 v12, 3840, v12
    v_add_u32 v12, s34, v12
    v_and_b32 v10, 1, v1
    v_lshl_add_u32 v13, v11, 1, v10
    v_min_u32 v13, 14, v13
    v_mul_u32_u24 v14, 13, v13
    v_lshrrev_b32 v14, 6, v14
    v_mul_u32_u24 v14, 1200, v14
    v_lshl_add_u32 v13, v13, 4, v14
    v_add_u32 v6, v13, v12
    v_add_u32 v7, 14336, v6
    v_xor_b32 v11, 4, v11
    v_lshl_add_u32 v13, v11, 1, v10
    v_min_u32 v13, 14, v13
    v_mul_u32_u24 v14, 13, v13
    v_lshrrev_b32 v14, 6, v14
    v_mul_u32_u24 v14, 1200, v14
    v_lshl_add_u32 v13, v13, 4, v14
    v_add_u32 v8, v13, v12
    v_add_u32 v8, 28672, v8
    v_add_u32 v9, 14336, v8
    s_lshl_b32 s51, s50, 13
    s_lshl_b32 s52, s50, 12
    s_cmp_eq_u32 s28, 0
    s_waitcnt lgkmcnt(0)
    s_cselect_b32 s4, s64, s70
    s_cselect_b32 s5, s65, s71
    s_cselect_b32 s8, s66, s72
    s_cselect_b32 s9, s67, s73
    s_cselect_b32 s12, s68, s74
    s_cselect_b32 s13, s69, s75
    s_mov_b32 s16, s76
    s_mov_b32 s17, s77
    s_mov_b32 s24, s78
    s_mov_b32 s25, s79
    s_mov_b32 s20, s80
    s_mov_b32 s21, s81
    s_cmp_eq_u32 s57, 1
    s_cselect_b32 s84, s8, s4
    s_cselect_b32 s85, s9, s5
    s_cselect_b32 s86, s10, s6
    s_mov_b32 s87, 0x20000
    s_cselect_b32 s96, s70, s72
    s_cselect_b32 s97, s71, s73
    s_cselect_b32 s98, s6, s10
    s_mov_b32 s99, 0x20000
    s_cselect_b32 s42, s72, s70
    s_cselect_b32 s43, s73, s71
    s_cselect_b32 s100, s66, s64
    s_cselect_b32 s101, s67, s65
    s_cmp_eq_u32 s28, 0
    s_cselect_b32 s59, s59, 0
    s_cselect_b32 s58, s58, 0
    s_cselect_b32 s88, s88, 1
    s_cselect_b32 s89, s89, 0
    s_mov_b64 exec, s[90:91]
    buffer_load_dword v0, v17, s[96:99], s63 offen
    s_add_u32 s63, s63, s56
    buffer_load_dword v0, v17, s[96:99], s63 offen
    s_add_u32 s63, s63, s56
    s_mov_b64 exec, -1
    s_mov_b64 exec, s[88:89]
    buffer_load_dword v0, v15, s[84:87], s58 offen
    s_add_u32 s58, s58, s59
    buffer_load_dword v0, v15, s[84:87], s58 offen
    s_add_u32 s58, s58, s59
    s_mov_b64 exec, -1
    s_add_u32 m0, s52, 32768
    s_mov_b32 s33, 0
    buffer_load_dwordx4 v6, s[8:11], s33 offen offset:0 lds
    buffer_load_dwordx4 v7, s[8:11], s33 offen offset:1024 lds
    buffer_load_dwordx4 v8, s[8:11], s33 offen offset:2048 lds
    buffer_load_dwordx4 v9, s[8:11], s33 offen offset:3072 lds
    s_add_u32 m0, s51, 0
    s_mov_b32 s33, 0
    buffer_load_dwordx4 v2, s[4:7], s33 offen offset:0 lds
    buffer_load_dwordx4 v3, s[4:7], s33 offen offset:1024 lds
    buffer_load_dwordx4 v4, s[4:7], s33 offen offset:2048 lds
    buffer_load_dwordx4 v5, s[4:7], s33 offen offset:3072 lds
    s_add_u32 m0, s51, 4096
    s_mov_b32 s33, 40960
    buffer_load_dwordx4 v2, s[4:7], s33 offen offset:0 lds
    buffer_load_dwordx4 v3, s[4:7], s33 offen offset:1024 lds
    buffer_load_dwordx4 v4, s[4:7], s33 offen offset:2048 lds
    buffer_load_dwordx4 v5, s[4:7], s33 offen offset:3072 lds
    s_add_u32 m0, s52, 81920
    s_mov_b32 s33, 245760
    buffer_load_dwordx4 v6, s[8:11], s33 offen offset:0 lds
    buffer_load_dwordx4 v7, s[8:11], s33 offen offset:1024 lds
    buffer_load_dwordx4 v8, s[8:11], s33 offen offset:2048 lds
    buffer_load_dwordx4 v9, s[8:11], s33 offen offset:3072 lds
    s_add_u32 m0, s51, 49152
    s_mov_b32 s33, 128
    buffer_load_dwordx4 v2, s[4:7], s33 offen offset:0 lds
    buffer_load_dwordx4 v3, s[4:7], s33 offen offset:1024 lds
    buffer_load_dwordx4 v4, s[4:7], s33 offen offset:2048 lds
    buffer_load_dwordx4 v5, s[4:7], s33 offen offset:3072 lds
    s_add_u32 m0, s51, 53248
    s_mov_b32 s33, 41088
    buffer_load_dwordx4 v2, s[4:7], s33 offen offset:0 lds
    buffer_load_dwordx4 v3, s[4:7], s33 offen offset:1024 lds
    buffer_load_dwordx4 v4, s[4:7], s33 offen offset:2048 lds
    buffer_load_dwordx4 v5, s[4:7], s33 offen offset:3072 lds
    s_waitcnt vmcnt(12)
    s_barrier
    s_mov_b64 exec, s[90:91]
    buffer_load_dword v0, v17, s[96:99], s63 offen
    s_add_u32 s63, s63, s56
    s_mov_b64 exec, -1
    s_cmp_eq_u32 s57, 1
    s_cselect_b32 s63, s63, 0
    s_cselect_b32 s56, s56, 0
    s_cselect_b32 s91, s91, 0
    s_cselect_b32 s90, s90, 1
    s_mov_b64 exec, s[90:91]
    buffer_load_dword v0, v17, s[96:99], s63 offen
    s_add_u32 s63, s63, s56
    buffer_load_dword v0, v17, s[96:99], s63 offen
    s_add_u32 s63, s63, s56
    s_mov_b64 exec, -1
    s_mov_b32 s96, s42
    s_mov_b32 s97, s43
    s_mov_b32 s98, s86
    v_mov_b32 v17, v15
    s_mul_i32 s63, s54, 3
    s_add_u32 s63, s63, s53
    s_andn2_b32 s33, s57, s28
    s_cmp_eq_u32 s33, 1
    s_cselect_b32 s63, s63, 0
    s_cselect_b32 s56, s54, 0
    s_cselect_b32 s91, s55, 0
    s_cselect_b32 s90, -1, 1
    s_mov_b64 exec, s[90:91]
    buffer_load_dword v0, v17, s[96:99], s63 offen
    s_add_u32 s63, s63, s56
    s_mov_b64 exec, -1
    s_add_u32 m0, s52, 131072
    s_mov_b32 s33, 491520
    buffer_load_dwordx4 v6, s[8:11], s33 offen offset:0 lds
    buffer_load_dwordx4 v7, s[8:11], s33 offen offset:1024 lds
    buffer_load_dwordx4 v8, s[8:11], s33 offen offset:2048 lds
    buffer_load_dwordx4 v9, s[8:11], s33 offen offset:3072 lds
    s_add_u32 m0, s51, 98304
    s_mov_b32 s33, 256
    buffer_load_dwordx4 v2, s[4:7], s33 offen offset:0 lds
    buffer_load_dwordx4 v3, s[4:7], s33 offen offset:1024 lds
    buffer_load_dwordx4 v4, s[4:7], s33 offen offset:2048 lds
    buffer_load_dwordx4 v5, s[4:7], s33 offen offset:3072 lds
    s_add_u32 m0, s51, 102400
    s_mov_b32 s33, 41216
    buffer_load_dwordx4 v2, s[4:7], s33 offen offset:0 lds
    buffer_load_dwordx4 v3, s[4:7], s33 offen offset:1024 lds
    buffer_load_dwordx4 v4, s[4:7], s33 offen offset:2048 lds
    buffer_load_dwordx4 v5, s[4:7], s33 offen offset:3072 lds
    s_mov_b64 exec, s[88:89]
    buffer_load_dword v0, v15, s[84:87], s58 offen
    s_add_u32 s58, s58, s59
    s_mov_b64 exec, -1
    s_waitcnt vmcnt(17)
    s_barrier
    s_mov_b64 exec, s[90:91]
    buffer_load_dword v0, v17, s[96:99], s63 offen
    s_add_u32 s63, s63, s56
    s_mov_b64 exec, -1
    s_add_u32 m0, s52, 32768
    s_mov_b32 s33, 737280
    buffer_load_dwordx4 v6, s[8:11], s33 offen offset:0 lds
    buffer_load_dwordx4 v7, s[8:11], s33 offen offset:1024 lds
    buffer_load_dwordx4 v8, s[8:11], s33 offen offset:2048 lds
    buffer_load_dwordx4 v9, s[8:11], s33 offen offset:3072 lds
    s_add_u32 m0, s51, 0
    s_mov_b32 s33, 384
    buffer_load_dwordx4 v2, s[4:7], s33 offen offset:0 lds
    buffer_load_dwordx4 v3, s[4:7], s33 offen offset:1024 lds
    buffer_load_dwordx4 v4, s[4:7], s33 offen offset:2048 lds
    buffer_load_dwordx4 v5, s[4:7], s33 offen offset:3072 lds
    s_add_u32 m0, s51, 4096
    s_mov_b32 s33, 41344
    buffer_load_dwordx4 v2, s[4:7], s33 offen offset:0 lds
    buffer_load_dwordx4 v3, s[4:7], s33 offen offset:1024 lds
    buffer_load_dwordx4 v4, s[4:7], s33 offen offset:2048 lds
    buffer_load_dwordx4 v5, s[4:7], s33 offen offset:3072 lds
    s_waitcnt vmcnt(14)
    s_barrier
    s_add_u32 m0, s52, 81920
    s_mov_b32 s33, 983040
    buffer_load_dwordx4 v6, s[8:11], s33 offen offset:0 lds
    buffer_load_dwordx4 v7, s[8:11], s33 offen offset:1024 lds
    buffer_load_dwordx4 v8, s[8:11], s33 offen offset:2048 lds
    buffer_load_dwordx4 v9, s[8:11], s33 offen offset:3072 lds
    s_add_u32 m0, s51, 49152
    s_mov_b32 s33, 512
    buffer_load_dwordx4 v2, s[4:7], s33 offen offset:0 lds
    buffer_load_dwordx4 v3, s[4:7], s33 offen offset:1024 lds
    buffer_load_dwordx4 v4, s[4:7], s33 offen offset:2048 lds
    buffer_load_dwordx4 v5, s[4:7], s33 offen offset:3072 lds
    s_add_u32 m0, s51, 53248
    s_mov_b32 s33, 41472
    buffer_load_dwordx4 v2, s[4:7], s33 offen offset:0 lds
    buffer_load_dwordx4 v3, s[4:7], s33 offen offset:1024 lds
    buffer_load_dwordx4 v4, s[4:7], s33 offen offset:2048 lds
    buffer_load_dwordx4 v5, s[4:7], s33 offen offset:3072 lds
    s_waitcnt vmcnt(12)
    s_barrier
    s_add_u32 m0, s52, 131072
    s_mov_b32 s33, 1228800
    buffer_load_dwordx4 v6, s[8:11], s33 offen offset:0 lds
    buffer_load_dwordx4 v7, s[8:11], s33 offen offset:1024 lds
    buffer_load_dwordx4 v8, s[8:11], s33 offen offset:2048 lds
    buffer_load_dwordx4 v9, s[8:11], s33 offen offset:3072 lds
    s_add_u32 m0, s51, 98304
    s_mov_b32 s33, 640
    buffer_load_dwordx4 v2, s[4:7], s33 offen offset:0 lds
    buffer_load_dwordx4 v3, s[4:7], s33 offen offset:1024 lds
    buffer_load_dwordx4 v4, s[4:7], s33 offen offset:2048 lds
    buffer_load_dwordx4 v5, s[4:7], s33 offen offset:3072 lds
    s_add_u32 m0, s51, 102400
    s_mov_b32 s33, 41600
    buffer_load_dwordx4 v2, s[4:7], s33 offen offset:0 lds
    buffer_load_dwordx4 v3, s[4:7], s33 offen offset:1024 lds
    buffer_load_dwordx4 v4, s[4:7], s33 offen offset:2048 lds
    buffer_load_dwordx4 v5, s[4:7], s33 offen offset:3072 lds
    s_waitcnt vmcnt(12)
    s_barrier
    s_add_u32 m0, s52, 32768
    s_mov_b32 s33, 1474560
    buffer_load_dwordx4 v6, s[8:11], s33 offen offset:0 lds
    buffer_load_dwordx4 v7, s[8:11], s33 offen offset:1024 lds
    buffer_load_dwordx4 v8, s[8:11], s33 offen offset:2048 lds
    buffer_load_dwordx4 v9, s[8:11], s33 offen offset:3072 lds
    s_add_u32 m0, s51, 0
    s_mov_b32 s33, 768
    buffer_load_dwordx4 v2, s[4:7], s33 offen offset:0 lds
    buffer_load_dwordx4 v3, s[4:7], s33 offen offset:1024 lds
    buffer_load_dwordx4 v4, s[4:7], s33 offen offset:2048 lds
    buffer_load_dwordx4 v5, s[4:7], s33 offen offset:3072 lds
    s_add_u32 m0, s51, 4096
    s_mov_b32 s33, 41728
    buffer_load_dwordx4 v2, s[4:7], s33 offen offset:0 lds
    buffer_load_dwordx4 v3, s[4:7], s33 offen offset:1024 lds
    buffer_load_dwordx4 v4, s[4:7], s33 offen offset:2048 lds
    buffer_load_dwordx4 v5, s[4:7], s33 offen offset:3072 lds
    s_waitcnt vmcnt(12)
    s_barrier
    s_add_u32 m0, s52, 81920
    s_mov_b32 s33, 1720320
    buffer_load_dwordx4 v6, s[8:11], s33 offen offset:0 lds
    buffer_load_dwordx4 v7, s[8:11], s33 offen offset:1024 lds
    buffer_load_dwordx4 v8, s[8:11], s33 offen offset:2048 lds
    buffer_load_dwordx4 v9, s[8:11], s33 offen offset:3072 lds
    s_add_u32 m0, s51, 49152
    s_mov_b32 s33, 896
    buffer_load_dwordx4 v2, s[4:7], s33 offen offset:0 lds
    buffer_load_dwordx4 v3, s[4:7], s33 offen offset:1024 lds
    buffer_load_dwordx4 v4, s[4:7], s33 offen offset:2048 lds
    buffer_load_dwordx4 v5, s[4:7], s33 offen offset:3072 lds
    s_add_u32 m0, s51, 53248
    s_mov_b32 s33, 41856
    buffer_load_dwordx4 v2, s[4:7], s33 offen offset:0 lds
    buffer_load_dwordx4 v3, s[4:7], s33 offen offset:1024 lds
    buffer_load_dwordx4 v4, s[4:7], s33 offen offset:2048 lds
    buffer_load_dwordx4 v5, s[4:7], s33 offen offset:3072 lds
    s_waitcnt vmcnt(12)
    s_barrier
    s_add_u32 m0, s52, 131072
    s_mov_b32 s33, 1966080
    buffer_load_dwordx4 v6, s[8:11], s33 offen offset:0 lds
    buffer_load_dwordx4 v7, s[8:11], s33 offen offset:1024 lds
    buffer_load_dwordx4 v8, s[8:11], s33 offen offset:2048 lds
    buffer_load_dwordx4 v9, s[8:11], s33 offen offset:3072 lds
    s_add_u32 m0, s51, 98304
    s_mov_b32 s33, 1024
    buffer_load_dwordx4 v2, s[4:7], s33 offen offset:0 lds
    buffer_load_dwordx4 v3, s[4:7], s33 offen offset:1024 lds
    buffer_load_dwordx4 v4, s[4:7], s33 offen offset:2048 lds
    buffer_load_dwordx4 v5, s[4:7], s33 offen offset:3072 lds
    s_add_u32 m0, s51, 102400
    s_mov_b32 s33, 41984
    buffer_load_dwordx4 v2, s[4:7], s33 offen offset:0 lds
    buffer_load_dwordx4 v3, s[4:7], s33 offen offset:1024 lds
    buffer_load_dwordx4 v4, s[4:7], s33 offen offset:2048 lds
    buffer_load_dwordx4 v5, s[4:7], s33 offen offset:3072 lds
    s_waitcnt vmcnt(12)
    s_barrier
    s_add_u32 m0, s52, 32768
    s_mov_b32 s33, 2211840
    buffer_load_dwordx4 v6, s[8:11], s33 offen offset:0 lds
    buffer_load_dwordx4 v7, s[8:11], s33 offen offset:1024 lds
    buffer_load_dwordx4 v8, s[8:11], s33 offen offset:2048 lds
    buffer_load_dwordx4 v9, s[8:11], s33 offen offset:3072 lds
    s_add_u32 m0, s51, 0
    s_mov_b32 s33, 1152
    buffer_load_dwordx4 v2, s[4:7], s33 offen offset:0 lds
    buffer_load_dwordx4 v3, s[4:7], s33 offen offset:1024 lds
    buffer_load_dwordx4 v4, s[4:7], s33 offen offset:2048 lds
    buffer_load_dwordx4 v5, s[4:7], s33 offen offset:3072 lds
    s_add_u32 m0, s51, 4096
    s_mov_b32 s33, 42112
    buffer_load_dwordx4 v2, s[4:7], s33 offen offset:0 lds
    buffer_load_dwordx4 v3, s[4:7], s33 offen offset:1024 lds
    buffer_load_dwordx4 v4, s[4:7], s33 offen offset:2048 lds
    buffer_load_dwordx4 v5, s[4:7], s33 offen offset:3072 lds
    s_mov_b32 s96, s100
    s_mov_b32 s97, s101
    s_mov_b32 s98, s86
    v_mov_b32 v17, v15
    s_mul_i32 s63, s54, 3
    s_add_u32 s63, s63, s53
    s_cmp_eq_u32 s28, 1
    s_cselect_b32 s63, s63, 0
    s_cselect_b32 s56, s54, 0
    s_cselect_b32 s91, s55, 0
    s_cselect_b32 s90, -1, 1
    s_mov_b64 exec, s[90:91]
    buffer_load_dword v0, v17, s[96:99], s63 offen
    s_add_u32 s63, s63, s56
    buffer_load_dword v0, v17, s[96:99], s63 offen
    s_add_u32 s63, s63, s56
    s_mov_b64 exec, -1
    v_mov_b32 v10, v16
    s_mov_b32 exec_hi, 0x3ffff
    buffer_load_dword v0, v10, s[12:15], s60 offen
    s_mov_b64 exec, -1
    v_mul_u32_u24 v10, 6554, v1
    v_lshrrev_b32 v10, 16, v10
    v_mul_u32_u24 v11, 1120, v10
    v_lshl_add_u32 v11, v1, 4, v11
    s_mul_i32 s33, s31, 6400
    s_lshr_b32 s38, s30, 1
    s_mul_i32 s38, s38, 160
    s_add_u32 s33, s33, s38
    v_add_u32 v19, s33, v11
    s_waitcnt vmcnt(15)
    s_barrier
    s_waitcnt vmcnt(3)
    s_barrier
    s_lshr_b32 s33, s50, 1
    s_mul_i32 s33, s33, 53248
    s_and_b32 s34, s50, 1
    s_mul_i32 s34, s34, 13312
    s_add_u32 s33, s33, s34
    s_add_u32 s33, s33, 26624
    s_add_u32 s33, s33, s92
    v_lshrrev_b32 v10, 5, v1
    v_and_b32 v11, 31, v1
    v_mul_u32_u24 v10, 3328, v10
    v_mul_u32_u24 v11, 48, v11
    v_add3_u32 v10, v10, v11, s33
    v_lshrrev_b32 v12, 4, v1
    v_and_b32 v11, 15, v1
    v_mul_u32_u24 v12, 3328, v12
    v_lshlrev_b32 v11, 2, v11
    v_add3_u32 v12, v12, v11, s33
    v_mov_b32 v16, 0x3f803f80
    v_mov_b32 v17, 0x3f80
    s_barrier
    ds_write_b64 v10, v[16:17] offset:40
    ds_write_b64 v10, v[16:17] offset:6696
    ds_write_b32 v12, v16 offset:3136
    s_mov_b32 exec_hi, 0x3ffff
    s_mov_b32 s33, 0
    buffer_load_dwordx4 a[16:19], v19, s[12:15], s33 offen
    s_mov_b32 s33, 51200
    buffer_load_dwordx4 a[20:23], v19, s[12:15], s33 offen
    s_mov_b32 s33, 102400
    buffer_load_dwordx4 a[24:27], v19, s[12:15], s33 offen
    s_mov_b32 s33, 153600
    buffer_load_dwordx4 a[28:31], v19, s[12:15], s33 offen
    s_mov_b32 s33, 204800
    buffer_load_dwordx4 a[32:35], v19, s[12:15], s33 offen
    s_mov_b32 s33, 256000
    buffer_load_dwordx4 a[36:39], v19, s[12:15], s33 offen
    s_mov_b32 s33, 307200
    buffer_load_dwordx4 a[40:43], v19, s[12:15], s33 offen
    s_mov_b32 s33, 358400
    buffer_load_dwordx4 a[44:47], v19, s[12:15], s33 offen
    s_mov_b32 s33, 409600
    buffer_load_dwordx4 a[48:51], v19, s[12:15], s33 offen
    s_mov_b32 s33, 460800
    buffer_load_dwordx4 a[52:55], v19, s[12:15], s33 offen
    s_mov_b32 s33, 512000
    buffer_load_dwordx4 a[56:59], v19, s[12:15], s33 offen
    s_mov_b32 s33, 563200
    buffer_load_dwordx4 a[60:63], v19, s[12:15], s33 offen
    s_mov_b32 s33, 614400
    buffer_load_dwordx4 a[64:67], v19, s[12:15], s33 offen
    s_mov_b32 s33, 665600
    buffer_load_dwordx4 a[68:71], v19, s[12:15], s33 offen
    s_mov_b32 s33, 716800
    buffer_load_dwordx4 a[72:75], v19, s[12:15], s33 offen
    s_mov_b32 s33, 768000
    buffer_load_dwordx4 a[76:79], v19, s[12:15], s33 offen
    s_mov_b64 exec, -1
    s_branch L_join1
L_compute:
    s_cmp_lg_u32 s31, 2
    s_cbranch_scc1 L_nocpf
    s_getpc_b64 s[60:61]
L_pc:
    s_sub_u32 s60, s60, L_pc - concat_heads__sliding_local_dilated__sliding_block__prompt_kernel
    s_subb_u32 s61, s61, 0
    v_lshlrev_b32 v26, 7, v1
    v_min_u32 v25, L_fallback - concat_heads__sliding_local_dilated__sliding_block__prompt_kernel, v26
    global_load_dword v0, v25, s[60:61]
    v_add_u32 v26, 0x2000, v26
    v_min_u32 v25, L_fallback - concat_heads__sliding_local_dilated__sliding_block__prompt_kernel, v26
    global_load_dword v0, v25, s[60:61]
    v_add_u32 v26, 0x2000, v26
    v_min_u32 v25, L_fallback - concat_heads__sliding_local_dilated__sliding_block__prompt_kernel, v26
    global_load_dword v0, v25, s[60:61]
    v_add_u32 v26, 0x2000, v26
L_nocpf:
    s_cmp_eq_u32 s28, 0
    s_waitcnt lgkmcnt(0)
    s_cselect_b32 s4, s64, s70
    s_cselect_b32 s5, s65, s71
    s_cselect_b32 s8, s66, s72
    s_cselect_b32 s9, s67, s73
    s_cselect_b32 s12, s68, s74
    s_cselect_b32 s13, s69, s75
    s_mov_b32 s16, s76
    s_mov_b32 s17, s77
    s_mov_b32 s24, s78
    s_mov_b32 s25, s79
    s_mov_b32 s20, s80
    s_mov_b32 s21, s81
    v_mov_b32 v27, 0
    s_cmp_lg_u32 s31, 3
    s_cbranch_scc1 L_notag
    s_cmp_lg_u32 s2, 0
    s_cbranch_scc1 L_notag
    s_memrealtime s[48:49]
    s_waitcnt lgkmcnt(0)
    s_or_b32 s48, s48, 1
    v_mov_b32 v28, s48
    v_mov_b32 v29, s49
    s_mov_b64 exec, 1
    buffer_store_dwordx2 v[28:29], v27, s[24:27], 0 offen sc1
    s_mov_b64 exec, -1
L_notag:
    s_cmp_eq_u32 s31, 3
    s_cselect_b32 s62, 8, 99
    s_mov_b32 s57, 4294868992
    v_and_b32 v20, 15, v1
    v_lshrrev_b32 v21, 4, v1
    v_lshrrev_b32 v23, 1, v20
    v_xor_b32 v23, v23, v21
    v_lshlrev_b32 v23, 4, v23
    v_lshl_add_u32 v23, v20, 7, v23
    s_lshl_b32 s33, s31, 13
    v_add_u32 v2, s33, v23
    v_xor_b32 v3, 64, v2
    v_lshrrev_b32 v23, 2, v20
    v_and_b32 v32, 1, v21
    v_lshl_add_u32 v22, v32, 2, v23
    v_lshl_add_u32 v23, v21, 3, v23
    v_lshlrev_b32 v23, 8, v23
    v_and_b32 v32, 3, v20
    v_lshl_add_u32 v23, v32, 3, v23
    v_add_u32 v23, 32768, v23
    v_xor_b32 v32, 0, v22
    v_lshl_add_u32 v4, v32, 5, v23
    v_xor_b32 v32, 1, v22
    v_lshl_add_u32 v5, v32, 5, v23
    v_xor_b32 v32, 2, v22
    v_lshl_add_u32 v6, v32, 5, v23
    v_xor_b32 v32, 3, v22
    v_lshl_add_u32 v7, v32, 5, v23
    v_xor_b32 v32, 4, v22
    v_lshl_add_u32 v8, v32, 5, v23
    v_xor_b32 v32, 5, v22
    v_lshl_add_u32 v9, v32, 5, v23
    v_xor_b32 v32, 6, v22
    v_lshl_add_u32 v10, v32, 5, v23
    v_xor_b32 v32, 7, v22
    v_lshl_add_u32 v11, v32, 5, v23
    s_mul_i32 s33, s31, 6656
    s_add_u32 s33, s33, s92
    v_mul_u32_u24 v33, 48, v20
    v_add_u32 v33, s33, v33
    s_mov_b32 s35, 0x3154
    v_add_u32 v23, 0, v21
    v_mul_u32_u24 v32, 13, v23
    v_lshrrev_b32 v32, 6, v32
    v_lshl_add_u32 v23, v23, 3, v33
    v_mul_u32_u24 v12, 40, v32
    v_sub_u32 v23, v23, v12
    v_lshlrev_b32 v32, 2, v32
    v_bfe_u32 v32, s35, v32, 4
    v_mul_u32_u24 v32, 26624, v32
    v_add_u32 v12, v23, v32
    v_add_u32 v23, 4, v21
    v_mul_u32_u24 v32, 13, v23
    v_lshrrev_b32 v32, 6, v32
    v_lshl_add_u32 v23, v23, 3, v33
    v_mul_u32_u24 v13, 40, v32
    v_sub_u32 v23, v23, v13
    v_lshlrev_b32 v32, 2, v32
    v_bfe_u32 v32, s35, v32, 4
    v_mul_u32_u24 v32, 26624, v32
    v_add_u32 v13, v23, v32
    v_add_u32 v23, 8, v21
    v_mul_u32_u24 v32, 13, v23
    v_lshrrev_b32 v32, 6, v32
    v_lshl_add_u32 v23, v23, 3, v33
    v_mul_u32_u24 v14, 40, v32
    v_sub_u32 v23, v23, v14
    v_lshlrev_b32 v32, 2, v32
    v_bfe_u32 v32, s35, v32, 4
    v_mul_u32_u24 v32, 26624, v32
    v_add_u32 v14, v23, v32
    v_add_u32 v23, 12, v21
    v_mul_u32_u24 v32, 13, v23
    v_lshrrev_b32 v32, 6, v32
    v_lshl_add_u32 v23, v23, 3, v33
    v_mul_u32_u24 v15, 40, v32
    v_sub_u32 v23, v23, v15
    v_lshlrev_b32 v32, 2, v32
    v_bfe_u32 v32, s35, v32, 4
    v_mul_u32_u24 v32, 26624, v32
    v_add_u32 v15, v23, v32
    v_add_u32 v23, 16, v21
    v_mul_u32_u24 v32, 13, v23
    v_lshrrev_b32 v32, 6, v32
    v_lshl_add_u32 v23, v23, 3, v33
    v_mul_u32_u24 v16, 40, v32
    v_sub_u32 v23, v23, v16
    v_lshlrev_b32 v32, 2, v32
    v_bfe_u32 v32, s35, v32, 4
    v_mul_u32_u24 v32, 26624, v32
    v_add_u32 v16, v23, v32
    v_and_b32 v23, 1, v21
    v_lshrrev_b32 v32, 1, v21
    v_lshl_add_u32 v33, v23, 1, v32
    v_lshlrev_b32 v33, 3, v33
    s_add_u32 s34, s33, 28160
    v_add_u32 v33, s34, v33
    v_add_u32 v23, 0, v20
    v_mul_u32_u24 v32, 205, v23
    v_lshrrev_b32 v32, 12, v32
    v_mul_u32_u24 v23, 80, v23
    v_mul_u32_u24 v32, 51648, v32
    v_add3_u32 v17, v23, v32, v33
    v_add_u32 v23, 16, v20
    v_mul_u32_u24 v32, 205, v23
    v_lshrrev_b32 v32, 12, v32
    v_mul_u32_u24 v23, 80, v23
    v_mul_u32_u24 v32, 51648, v32
    v_add3_u32 v18, v23, v32, v33
    v_add_u32 v23, 32, v20
    v_mul_u32_u24 v32, 205, v23
    v_lshrrev_b32 v32, 12, v32
    v_mul_u32_u24 v23, 80, v23
    v_mul_u32_u24 v32, 51648, v32
    v_add3_u32 v24, v23, v32, v33
    v_mul_u32_u24 v23, 6554, v1
    v_lshrrev_b32 v23, 16, v23
    v_mul_u32_u24 v32, 1120, v23
    v_lshl_add_u32 v32, v1, 4, v32
    s_mul_i32 s33, s31, 6400
    s_lshr_b32 s38, s30, 1
    s_mul_i32 s38, s38, 160
    s_add_u32 s33, s33, s38
    v_add_u32 v19, s33, v32
    v_cmp_gt_u32 vcc, 32, v1
    v_mov_b32 v23, 0x3ea52b5c
    s_nop 0
    v_cndmask_b32 v22, 1.0, v23, vcc
    v_mov_b32 v23, v22
    v_mov_b32 v32, 0
    v_mov_b32 v33, 0
    v_mov_b32 v34, 0
    v_mov_b32 v35, 0
    v_mov_b32 v36, 0
    v_mov_b32 v37, 0
    v_mov_b32 v38, 0
    v_mov_b32 v39, 0
    v_mov_b32 v40, 0
    v_mov_b32 v41, 0
    v_mov_b32 v42, 0
    v_mov_b32 v43, 0
    v_mov_b32 v44, 0
    v_mov_b32 v45, 0
    v_mov_b32 v46, 0
    v_mov_b32 v47, 0
    v_mov_b32 v48, 0
    v_mov_b32 v49, 0
    v_mov_b32 v50, 0
    v_mov_b32 v51, 0
    v_mov_b32 v52, 0
    v_mov_b32 v53, 0
    v_mov_b32 v54, 0
    v_mov_b32 v55, 0
    v_mov_b32 v56, 0
    v_mov_b32 v57, 0
    v_mov_b32 v58, 0
    v_mov_b32 v59, 0
    v_mov_b32 v60, 0
    v_mov_b32 v61, 0
    v_mov_b32 v62, 0
    v_mov_b32 v63, 0
    v_mov_b32 v64, 0
    v_mov_b32 v65, 0
    v_mov_b32 v66, 0
    v_mov_b32 v67, 0
    v_mov_b32 v68, 0
    v_mov_b32 v69, 0
    v_mov_b32 v70, 0
    v_mov_b32 v71, 0
    v_mov_b32 v72, 0
    v_mov_b32 v73, 0
    v_mov_b32 v74, 0
    v_mov_b32 v75, 0
    v_mov_b32 v76, 0
    v_mov_b32 v77, 0
    v_mov_b32 v78, 0
    v_mov_b32 v79, 0
    v_mov_b32 v80, 0
    v_mov_b32 v81, 0
    v_mov_b32 v82, 0
    v_mov_b32 v83, 0
    v_mov_b32 v84, 0
    v_mov_b32 v85, 0
    v_mov_b32 v86, 0
    v_mov_b32 v87, 0
    v_mov_b32 v88, 0
    v_mov_b32 v89, 0
    v_mov_b32 v90, 0
    v_mov_b32 v91, 0
    v_mov_b32 v92, 0
    v_mov_b32 v93, 0
    v_mov_b32 v94, 0
    v_mov_b32 v95, 0
    v_mov_b32 v96, 0
    v_mov_b32 v97, 0
    v_mov_b32 v98, 0
    v_mov_b32 v99, 0
    v_mov_b32 v100, 0
    v_mov_b32 v101, 0
    v_mov_b32 v102, 0
    v_mov_b32 v103, 0
    v_mov_b32 v104, 0
    v_mov_b32 v105, 0
    v_mov_b32 v106, 0
    v_mov_b32 v107, 0
    v_mov_b32 v108, 0
    v_mov_b32 v109, 0
    v_mov_b32 v110, 0
    v_mov_b32 v111, 0
    v_mov_b32 v112, 0
    v_mov_b32 v113, 0
    v_mov_b32 v114, 0
    v_mov_b32 v115, 0
    v_mov_b32 v116, 0
    v_mov_b32 v117, 0
    v_mov_b32 v118, 0
    v_mov_b32 v119, 0
    v_mov_b32 v120, 0
    v_mov_b32 v121, 0
    v_mov_b32 v122, 0
    v_mov_b32 v123, 0
    v_mov_b32 v124, 0
    v_mov_b32 v125, 0
    v_mov_b32 v126, 0
    v_mov_b32 v127, 0
    v_mov_b32 v128, 0
    v_mov_b32 v129, 0
    v_mov_b32 v130, 0
    v_mov_b32 v131, 0
    v_mov_b32 v132, 0
    v_mov_b32 v133, 0
    v_mov_b32 v134, 0
    v_mov_b32 v135, 0
    v_mov_b32 v136, 0
    v_mov_b32 v137, 0
    v_mov_b32 v138, 0
    v_mov_b32 v139, 0
    v_mov_b32 v140, 0
    v_mov_b32 v141, 0
    v_mov_b32 v142, 0
    v_mov_b32 v143, 0
    v_mov_b32 v144, 0
    v_mov_b32 v145, 0
    v_mov_b32 v146, 0
    v_mov_b32 v147, 0
    v_mov_b32 v148, 0
    v_mov_b32 v149, 0
    v_mov_b32 v150, 0
    v_mov_b32 v151, 0
    v_mov_b32 v152, 0
    v_mov_b32 v153, 0
    v_mov_b32 v154, 0
    v_mov_b32 v155, 0
    v_mov_b32 v156, 0
    v_mov_b32 v157, 0
    v_mov_b32 v158, 0
    v_mov_b32 v159, 0
    s_mov_b32 s52, 0
    s_mov_b32 s54, 0
    s_barrier
    ds_read_b128 a[0:3], v2 offset:0
    ds_read_b128 a[4:7], v2 offset:2048
    ds_read_b128 a[8:11], v2 offset:4096
    ds_read_b128 a[12:15], v2 offset:6144
    ds_read_b64_tr_b16 a[16:17], v4 offset:0
    ds_read_b64_tr_b16 a[18:19], v4 offset:1024
    ds_read_b64_tr_b16 a[20:21], v5 offset:0
    ds_read_b64_tr_b16 a[22:23], v5 offset:1024
    ds_read_b64_tr_b16 a[24:25], v6 offset:0
    ds_read_b64_tr_b16 a[26:27], v6 offset:1024
    ds_read_b64_tr_b16 a[28:29], v7 offset:0
    ds_read_b64_tr_b16 a[30:31], v7 offset:1024
    ds_read_b64_tr_b16 a[32:33], v8 offset:0
    ds_read_b64_tr_b16 a[34:35], v8 offset:1024
    ds_read_b64_tr_b16 a[36:37], v9 offset:0
    ds_read_b64_tr_b16 a[38:39], v9 offset:1024
    ds_read_b64_tr_b16 a[40:41], v10 offset:0
    ds_read_b64_tr_b16 a[42:43], v10 offset:1024
    ds_read_b64_tr_b16 a[44:45], v11 offset:0
    ds_read_b64_tr_b16 a[46:47], v11 offset:1024
    s_waitcnt lgkmcnt(0)
L_p1loop:
    v_mfma_f32_16x16x32_bf16 v[32:35], a[16:19], a[0:3], v[32:35]
    ds_read_b128 a[48:51], v3 offset:0
    v_mfma_f32_16x16x32_bf16 v[36:39], a[16:19], a[4:7], v[36:39]
    ds_read_b128 a[52:55], v3 offset:2048
    v_mfma_f32_16x16x32_bf16 v[40:43], a[16:19], a[8:11], v[40:43]
    ds_read_b128 a[56:59], v3 offset:4096
    v_mfma_f32_16x16x32_bf16 v[44:47], a[16:19], a[12:15], v[44:47]
    ds_read_b128 a[60:63], v3 offset:6144
    v_mfma_f32_16x16x32_bf16 v[48:51], a[20:23], a[0:3], v[48:51]
    ds_read_b64_tr_b16 a[64:65], v4 offset:8192
    v_mfma_f32_16x16x32_bf16 v[52:55], a[20:23], a[4:7], v[52:55]
    ds_read_b64_tr_b16 a[66:67], v4 offset:9216
    v_mfma_f32_16x16x32_bf16 v[56:59], a[20:23], a[8:11], v[56:59]
    ds_read_b64_tr_b16 a[68:69], v5 offset:8192
    v_mfma_f32_16x16x32_bf16 v[60:63], a[20:23], a[12:15], v[60:63]
    ds_read_b64_tr_b16 a[70:71], v5 offset:9216
    v_mfma_f32_16x16x32_bf16 v[64:67], a[24:27], a[0:3], v[64:67]
    ds_read_b64_tr_b16 a[72:73], v6 offset:8192
    v_mfma_f32_16x16x32_bf16 v[68:71], a[24:27], a[4:7], v[68:71]
    ds_read_b64_tr_b16 a[74:75], v6 offset:9216
    v_mfma_f32_16x16x32_bf16 v[72:75], a[24:27], a[8:11], v[72:75]
    ds_read_b64_tr_b16 a[76:77], v7 offset:8192
    v_mfma_f32_16x16x32_bf16 v[76:79], a[24:27], a[12:15], v[76:79]
    ds_read_b64_tr_b16 a[78:79], v7 offset:9216
    v_mfma_f32_16x16x32_bf16 v[80:83], a[28:31], a[0:3], v[80:83]
    ds_read_b64_tr_b16 a[80:81], v8 offset:8192
    v_mfma_f32_16x16x32_bf16 v[84:87], a[28:31], a[4:7], v[84:87]
    ds_read_b64_tr_b16 a[82:83], v8 offset:9216
    v_mfma_f32_16x16x32_bf16 v[88:91], a[28:31], a[8:11], v[88:91]
    ds_read_b64_tr_b16 a[84:85], v9 offset:8192
    v_mfma_f32_16x16x32_bf16 v[92:95], a[28:31], a[12:15], v[92:95]
    ds_read_b64_tr_b16 a[86:87], v9 offset:9216
    v_mfma_f32_16x16x32_bf16 v[96:99], a[32:35], a[0:3], v[96:99]
    ds_read_b64_tr_b16 a[88:89], v10 offset:8192
    v_mfma_f32_16x16x32_bf16 v[100:103], a[32:35], a[4:7], v[100:103]
    ds_read_b64_tr_b16 a[90:91], v10 offset:9216
    v_mfma_f32_16x16x32_bf16 v[104:107], a[32:35], a[8:11], v[104:107]
    ds_read_b64_tr_b16 a[92:93], v11 offset:8192
    v_mfma_f32_16x16x32_bf16 v[108:111], a[32:35], a[12:15], v[108:111]
    ds_read_b64_tr_b16 a[94:95], v11 offset:9216
    v_mfma_f32_16x16x32_bf16 v[112:115], a[0:3], a[36:39], v[112:115]
    s_add_u32 s54, s54, 1
    s_cmp_eq_u32 s54, 3
    s_cselect_b32 s53, s57, 49152
    s_cselect_b32 s54, 0, s54
    v_mfma_f32_16x16x32_bf16 v[116:119], a[4:7], a[36:39], v[116:119]
    v_mfma_f32_16x16x32_bf16 v[120:123], a[8:11], a[36:39], v[120:123]
    v_mfma_f32_16x16x32_bf16 v[124:127], a[12:15], a[36:39], v[124:127]
    v_mfma_f32_16x16x32_bf16 v[128:131], a[0:3], a[40:43], v[128:131]
    s_cmp_lg_u32 s52, s62
    s_cbranch_scc1 L_notagrd
    s_waitcnt vmcnt(0)
    buffer_load_dwordx2 v[28:29], v27, s[24:27], 0 offen sc1
L_notagrd:
    v_mfma_f32_16x16x32_bf16 v[132:135], a[4:7], a[40:43], v[132:135]
    v_mfma_f32_16x16x32_bf16 v[136:139], a[8:11], a[40:43], v[136:139]
    s_waitcnt lgkmcnt(0)
    s_barrier
    v_add_u32 v2, s53, v2
    v_add_u32 v3, s53, v3
    v_add_u32 v4, s53, v4
    v_add_u32 v5, s53, v5
    v_add_u32 v6, s53, v6
    v_add_u32 v7, s53, v7
    v_add_u32 v8, s53, v8
    v_add_u32 v9, s53, v9
    v_add_u32 v10, s53, v10
    v_add_u32 v11, s53, v11
    v_mfma_f32_16x16x32_bf16 v[140:143], a[12:15], a[40:43], v[140:143]
    v_mfma_f32_16x16x32_bf16 v[144:147], a[0:3], a[44:47], v[144:147]
    v_mfma_f32_16x16x32_bf16 v[148:151], a[4:7], a[44:47], v[148:151]
    v_mfma_f32_16x16x32_bf16 v[152:155], a[8:11], a[44:47], v[152:155]
    v_mfma_f32_16x16x32_bf16 v[156:159], a[12:15], a[44:47], v[156:159]
    s_cmp_eq_u32 s52, 9
    s_cbranch_scc1 L_tail
    v_mfma_f32_16x16x32_bf16 v[32:35], a[64:67], a[48:51], v[32:35]
    ds_read_b128 a[0:3], v2 offset:0
    v_mfma_f32_16x16x32_bf16 v[36:39], a[64:67], a[52:55], v[36:39]
    ds_read_b128 a[4:7], v2 offset:2048
    v_mfma_f32_16x16x32_bf16 v[40:43], a[64:67], a[56:59], v[40:43]
    ds_read_b128 a[8:11], v2 offset:4096
    v_mfma_f32_16x16x32_bf16 v[44:47], a[64:67], a[60:63], v[44:47]
    ds_read_b128 a[12:15], v2 offset:6144
    v_mfma_f32_16x16x32_bf16 v[48:51], a[68:71], a[48:51], v[48:51]
    ds_read_b64_tr_b16 a[16:17], v4 offset:0
    v_mfma_f32_16x16x32_bf16 v[52:55], a[68:71], a[52:55], v[52:55]
    ds_read_b64_tr_b16 a[18:19], v4 offset:1024
    v_mfma_f32_16x16x32_bf16 v[56:59], a[68:71], a[56:59], v[56:59]
    ds_read_b64_tr_b16 a[20:21], v5 offset:0
    v_mfma_f32_16x16x32_bf16 v[60:63], a[68:71], a[60:63], v[60:63]
    ds_read_b64_tr_b16 a[22:23], v5 offset:1024
    v_mfma_f32_16x16x32_bf16 v[64:67], a[72:75], a[48:51], v[64:67]
    ds_read_b64_tr_b16 a[24:25], v6 offset:0
    v_mfma_f32_16x16x32_bf16 v[68:71], a[72:75], a[52:55], v[68:71]
    ds_read_b64_tr_b16 a[26:27], v6 offset:1024
    v_mfma_f32_16x16x32_bf16 v[72:75], a[72:75], a[56:59], v[72:75]
    ds_read_b64_tr_b16 a[28:29], v7 offset:0
    v_mfma_f32_16x16x32_bf16 v[76:79], a[72:75], a[60:63], v[76:79]
    ds_read_b64_tr_b16 a[30:31], v7 offset:1024
    v_mfma_f32_16x16x32_bf16 v[80:83], a[76:79], a[48:51], v[80:83]
    ds_read_b64_tr_b16 a[32:33], v8 offset:0
    v_mfma_f32_16x16x32_bf16 v[84:87], a[76:79], a[52:55], v[84:87]
    ds_read_b64_tr_b16 a[34:35], v8 offset:1024
    v_mfma_f32_16x16x32_bf16 v[88:91], a[76:79], a[56:59], v[88:91]
    ds_read_b64_tr_b16 a[36:37], v9 offset:0
    v_mfma_f32_16x16x32_bf16 v[92:95], a[76:79], a[60:63], v[92:95]
    ds_read_b64_tr_b16 a[38:39], v9 offset:1024
    v_mfma_f32_16x16x32_bf16 v[96:99], a[80:83], a[48:51], v[96:99]
    ds_read_b64_tr_b16 a[40:41], v10 offset:0
    v_mfma_f32_16x16x32_bf16 v[100:103], a[80:83], a[52:55], v[100:103]
    ds_read_b64_tr_b16 a[42:43], v10 offset:1024
    v_mfma_f32_16x16x32_bf16 v[104:107], a[80:83], a[56:59], v[104:107]
    ds_read_b64_tr_b16 a[44:45], v11 offset:0
    v_mfma_f32_16x16x32_bf16 v[108:111], a[80:83], a[60:63], v[108:111]
    ds_read_b64_tr_b16 a[46:47], v11 offset:1024
    v_mfma_f32_16x16x32_bf16 v[112:115], a[48:51], a[84:87], v[112:115]
    v_mfma_f32_16x16x32_bf16 v[116:119], a[52:55], a[84:87], v[116:119]
    v_mfma_f32_16x16x32_bf16 v[120:123], a[56:59], a[84:87], v[120:123]
    v_mfma_f32_16x16x32_bf16 v[124:127], a[60:63], a[84:87], v[124:127]
    v_mfma_f32_16x16x32_bf16 v[128:131], a[48:51], a[88:91], v[128:131]
    v_mfma_f32_16x16x32_bf16 v[132:135], a[52:55], a[88:91], v[132:135]
    v_mfma_f32_16x16x32_bf16 v[136:139], a[56:59], a[88:91], v[136:139]
    v_mfma_f32_16x16x32_bf16 v[140:143], a[60:63], a[88:91], v[140:143]
    v_mfma_f32_16x16x32_bf16 v[144:147], a[48:51], a[92:95], v[144:147]
    v_mfma_f32_16x16x32_bf16 v[148:151], a[52:55], a[92:95], v[148:151]
    v_mfma_f32_16x16x32_bf16 v[152:155], a[56:59], a[92:95], v[152:155]
    v_mfma_f32_16x16x32_bf16 v[156:159], a[60:63], a[92:95], v[156:159]
    s_add_u32 s52, s52, 1
    s_cmp_lt_u32 s52, 10
    s_waitcnt lgkmcnt(0)
    s_cbranch_scc1 L_p1loop
L_tail:
    s_mov_b32 s34, 0x3ea52b5c
    s_mov_b32 s35, s34
    s_mov_b32 s36, 0x00ff00ff
    s_mov_b32 s37, 0x00ff00ff
    v_mfma_f32_16x16x32_bf16 v[32:35], a[64:67], a[48:51], v[32:35]
    v_mfma_f32_16x16x32_bf16 v[36:39], a[64:67], a[52:55], v[36:39]
    v_mfma_f32_16x16x32_bf16 v[40:43], a[64:67], a[56:59], v[40:43]
    v_mfma_f32_16x16x32_bf16 v[44:47], a[64:67], a[60:63], v[44:47]
    v_mfma_f32_16x16x32_bf16 v[48:51], a[68:71], a[48:51], v[48:51]
    s_nop 3
    v_pk_mul_f32 v[32:33], s[34:35], v[32:33]
    v_pk_mul_f32 v[34:35], s[34:35], v[34:35]
    v_cvt_pk_bf16_f32 v32, v32, v33
    v_cvt_pk_bf16_f32 v33, v34, v35
    ds_write_b64 v12, v[32:33] offset:0
    v_mfma_f32_16x16x32_bf16 v[52:55], a[68:71], a[52:55], v[52:55]
    v_pk_mul_f32 v[36:37], s[34:35], v[36:37]
    v_pk_mul_f32 v[38:39], s[34:35], v[38:39]
    v_cvt_pk_bf16_f32 v36, v36, v37
    v_cvt_pk_bf16_f32 v37, v38, v39
    ds_write_b64 v12, v[36:37] offset:768
    v_mfma_f32_16x16x32_bf16 v[56:59], a[68:71], a[56:59], v[56:59]
    v_pk_mul_f32 v[40:41], s[34:35], v[40:41]
    v_pk_mul_f32 v[42:43], s[34:35], v[42:43]
    v_cvt_pk_bf16_f32 v40, v40, v41
    v_cvt_pk_bf16_f32 v41, v42, v43
    ds_write_b64 v12, v[40:41] offset:3328
    v_mfma_f32_16x16x32_bf16 v[60:63], a[68:71], a[60:63], v[60:63]
    v_pk_mul_f32 v[44:45], s[34:35], v[44:45]
    v_pk_mul_f32 v[46:47], s[34:35], v[46:47]
    v_cvt_pk_bf16_f32 v44, v44, v45
    v_cvt_pk_bf16_f32 v45, v46, v47
    ds_write_b64 v12, v[44:45] offset:4096
    v_mfma_f32_16x16x32_bf16 v[64:67], a[72:75], a[48:51], v[64:67]
    v_pk_mul_f32 v[48:49], s[34:35], v[48:49]
    v_pk_mul_f32 v[50:51], s[34:35], v[50:51]
    v_cvt_pk_bf16_f32 v48, v48, v49
    v_cvt_pk_bf16_f32 v49, v50, v51
    ds_write_b64 v13, v[48:49] offset:0
    v_mfma_f32_16x16x32_bf16 v[68:71], a[72:75], a[52:55], v[68:71]
    v_pk_mul_f32 v[52:53], s[34:35], v[52:53]
    v_pk_mul_f32 v[54:55], s[34:35], v[54:55]
    v_cvt_pk_bf16_f32 v52, v52, v53
    v_cvt_pk_bf16_f32 v53, v54, v55
    ds_write_b64 v13, v[52:53] offset:768
    v_mfma_f32_16x16x32_bf16 v[72:75], a[72:75], a[56:59], v[72:75]
    v_pk_mul_f32 v[56:57], s[34:35], v[56:57]
    v_pk_mul_f32 v[58:59], s[34:35], v[58:59]
    v_cvt_pk_bf16_f32 v56, v56, v57
    v_cvt_pk_bf16_f32 v57, v58, v59
    ds_write_b64 v13, v[56:57] offset:3328
    v_mfma_f32_16x16x32_bf16 v[76:79], a[72:75], a[60:63], v[76:79]
    v_pk_mul_f32 v[60:61], s[34:35], v[60:61]
    v_pk_mul_f32 v[62:63], s[34:35], v[62:63]
    v_cvt_pk_bf16_f32 v60, v60, v61
    v_cvt_pk_bf16_f32 v61, v62, v63
    ds_write_b64 v13, v[60:61] offset:4096
    v_mfma_f32_16x16x32_bf16 v[80:83], a[76:79], a[48:51], v[80:83]
    v_pk_mul_f32 v[64:65], v[22:23], v[64:65]
    v_pk_mul_f32 v[66:67], v[22:23], v[66:67]
    v_cvt_pk_bf16_f32 v64, v64, v65
    v_cvt_pk_bf16_f32 v65, v66, v67
    ds_write_b64 v14, v[64:65] offset:0
    v_mfma_f32_16x16x32_bf16 v[84:87], a[76:79], a[52:55], v[84:87]
    v_pk_mul_f32 v[68:69], v[22:23], v[68:69]
    v_pk_mul_f32 v[70:71], v[22:23], v[70:71]
    v_cvt_pk_bf16_f32 v68, v68, v69
    v_cvt_pk_bf16_f32 v69, v70, v71
    ds_write_b64 v14, v[68:69] offset:768
    v_mfma_f32_16x16x32_bf16 v[88:91], a[76:79], a[56:59], v[88:91]
    v_pk_mul_f32 v[72:73], v[22:23], v[72:73]
    v_pk_mul_f32 v[74:75], v[22:23], v[74:75]
    v_cvt_pk_bf16_f32 v72, v72, v73
    v_cvt_pk_bf16_f32 v73, v74, v75
    ds_write_b64 v14, v[72:73] offset:3328
    v_mfma_f32_16x16x32_bf16 v[92:95], a[76:79], a[60:63], v[92:95]
    v_pk_mul_f32 v[76:77], v[22:23], v[76:77]
    v_pk_mul_f32 v[78:79], v[22:23], v[78:79]
    v_cvt_pk_bf16_f32 v76, v76, v77
    v_cvt_pk_bf16_f32 v77, v78, v79
    ds_write_b64 v14, v[76:77] offset:4096
    v_mfma_f32_16x16x32_bf16 v[96:99], a[80:83], a[48:51], v[96:99]
    v_cvt_pk_bf16_f32 v80, v80, v81
    v_cvt_pk_bf16_f32 v81, v82, v83
    ds_write_b64 v15, v[80:81] offset:0
    v_mfma_f32_16x16x32_bf16 v[100:103], a[80:83], a[52:55], v[100:103]
    v_cvt_pk_bf16_f32 v84, v84, v85
    v_cvt_pk_bf16_f32 v85, v86, v87
    ds_write_b64 v15, v[84:85] offset:768
    v_mfma_f32_16x16x32_bf16 v[104:107], a[80:83], a[56:59], v[104:107]
    v_cvt_pk_bf16_f32 v88, v88, v89
    v_cvt_pk_bf16_f32 v89, v90, v91
    ds_write_b64 v15, v[88:89] offset:3328
    v_mfma_f32_16x16x32_bf16 v[108:111], a[80:83], a[60:63], v[108:111]
    v_cvt_pk_bf16_f32 v92, v92, v93
    v_cvt_pk_bf16_f32 v93, v94, v95
    ds_write_b64 v15, v[92:93] offset:4096
    v_mfma_f32_16x16x32_bf16 v[112:115], a[48:51], a[84:87], v[112:115]
    v_cvt_pk_bf16_f32 v96, v96, v97
    v_cvt_pk_bf16_f32 v97, v98, v99
    ds_write_b64 v16, v[96:97] offset:0
    v_mfma_f32_16x16x32_bf16 v[116:119], a[52:55], a[84:87], v[116:119]
    v_cvt_pk_bf16_f32 v100, v100, v101
    v_cvt_pk_bf16_f32 v101, v102, v103
    ds_write_b64 v16, v[100:101] offset:768
    v_mfma_f32_16x16x32_bf16 v[120:123], a[56:59], a[84:87], v[120:123]
    v_cvt_pk_bf16_f32 v104, v104, v105
    v_cvt_pk_bf16_f32 v105, v106, v107
    ds_write_b64 v16, v[104:105] offset:3328
    v_mfma_f32_16x16x32_bf16 v[124:127], a[60:63], a[84:87], v[124:127]
    v_cvt_pk_bf16_f32 v108, v108, v109
    v_cvt_pk_bf16_f32 v109, v110, v111
    ds_write_b64 v16, v[108:109] offset:4096
    v_mfma_f32_16x16x32_bf16 v[128:131], a[48:51], a[88:91], v[128:131]
    v_cvt_pk_bf16_f32 v112, v112, v113
    v_cvt_pk_bf16_f32 v113, v114, v115
    ds_write_b64 v17, v[112:113] offset:0
    v_mfma_f32_16x16x32_bf16 v[132:135], a[52:55], a[88:91], v[132:135]
    v_cvt_pk_bf16_f32 v116, v116, v117
    v_cvt_pk_bf16_f32 v117, v118, v119
    ds_write_b64 v17, v[116:117] offset:32
    v_mfma_f32_16x16x32_bf16 v[136:139], a[56:59], a[88:91], v[136:139]
    v_cvt_pk_bf16_f32 v120, v120, v121
    v_cvt_pk_bf16_f32 v121, v122, v123
    ds_write_b64 v17, v[120:121] offset:3328
    v_mfma_f32_16x16x32_bf16 v[140:143], a[60:63], a[88:91], v[140:143]
    v_cvt_pk_bf16_f32 v124, v124, v125
    v_cvt_pk_bf16_f32 v125, v126, v127
    ds_write_b64 v17, v[124:125] offset:3360
    v_mfma_f32_16x16x32_bf16 v[144:147], a[48:51], a[92:95], v[144:147]
    v_cvt_pk_bf16_f32 v128, v128, v129
    v_cvt_pk_bf16_f32 v129, v130, v131
    ds_write_b64 v18, v[128:129] offset:0
    v_mfma_f32_16x16x32_bf16 v[148:151], a[52:55], a[92:95], v[148:151]
    v_cvt_pk_bf16_f32 v132, v132, v133
    v_cvt_pk_bf16_f32 v133, v134, v135
    ds_write_b64 v18, v[132:133] offset:32
    v_mfma_f32_16x16x32_bf16 v[152:155], a[56:59], a[92:95], v[152:155]
    v_cvt_pk_bf16_f32 v136, v136, v137
    v_cvt_pk_bf16_f32 v137, v138, v139
    ds_write_b64 v18, v[136:137] offset:3328
    v_mfma_f32_16x16x32_bf16 v[156:159], a[60:63], a[92:95], v[156:159]
    v_cvt_pk_bf16_f32 v140, v140, v141
    v_cvt_pk_bf16_f32 v141, v142, v143
    ds_write_b64 v18, v[140:141] offset:3360
    v_cvt_pk_bf16_f32 v144, v144, v145
    v_cvt_pk_bf16_f32 v145, v146, v147
    s_mov_b64 exec, s[36:37]
    ds_write_b64 v24, v[144:145] offset:0
    s_mov_b64 exec, -1
    v_cvt_pk_bf16_f32 v148, v148, v149
    v_cvt_pk_bf16_f32 v149, v150, v151
    s_mov_b64 exec, s[36:37]
    ds_write_b64 v24, v[148:149] offset:32
    s_mov_b64 exec, -1
    v_cvt_pk_bf16_f32 v152, v152, v153
    v_cvt_pk_bf16_f32 v153, v154, v155
    s_mov_b64 exec, s[36:37]
    ds_write_b64 v24, v[152:153] offset:3328
    s_mov_b64 exec, -1
    v_cvt_pk_bf16_f32 v156, v156, v157
    v_cvt_pk_bf16_f32 v157, v158, v159
    s_mov_b64 exec, s[36:37]
    ds_write_b64 v24, v[156:157] offset:3360
    s_mov_b64 exec, -1
    s_cmp_lg_u32 s31, 3
    s_cbranch_scc1 L_tagw
    s_mov_b32 s34, 0
L_tagpoll:
    s_waitcnt vmcnt(0)
    v_readfirstlane_b32 s33, v28
    s_add_u32 s34, s34, 1
    s_cmp_ge_u32 s34, 200000
    s_cbranch_scc1 L_tagok
    s_cmp_lg_u32 s33, 0
    s_cbranch_scc1 L_tagok
    buffer_load_dwordx2 v[28:29], v27, s[24:27], 0 offen sc1
    s_branch L_tagpoll
L_tagok:
    v_mov_b32 v27, 163776
    v_mov_b32 v30, 0
    v_mov_b32 v31, 0
    ds_write_b128 v27, v[28:31]
L_tagw:
L_join1:
    s_waitcnt lgkmcnt(0)
    s_barrier
    s_sub_u32 s33, 11, s31
    s_cmp_lt_u32 s31, 4
    s_cselect_b32 s50, s31, s33
    v_and_b32 v2, 31, v1
    s_mov_b32 s98, 0x07060302
    v_lshrrev_b32 v3, 5, v1
    v_mov_b32 v20, 163776
    ds_read_b64 v[4:5], v20
    s_mul_i32 s33, s50, 3328
    s_add_u32 s33, s33, 26624
    v_mul_u32_u24 v20, 48, v2
    v_add_u32 v20, s33, v20
    v_lshl_add_u32 v6, v3, 4, v20
    v_lshl_add_u32 v7, v3, 3, v20
    v_add_u32 v21, 79872, v6
    v_add_u32 v20, 79872, v20
    ds_read_b128 v[24:27], v21 offset:0
    ds_read_b64 v[28:29], v20 offset:32
    ds_read_b128 v[30:33], v21 offset:26624
    ds_read_b64 v[34:35], v20 offset:26656
    ds_read_b128 v[132:135], v6 offset:0
    ds_read_b64 v[136:137], v7 offset:32
    ds_read_b128 v[138:141], v6 offset:53248
    ds_read_b64 v[142:143], v7 offset:53280
    v_lshlrev_b32 v9, 4, v1
    v_min_u32 v21, 20, v2
    v_mul_u32_u24 v21, 80, v21
    v_lshl_add_u32 v21, v3, 4, v21
    v_add_u32 v8, s33, v21
    v_mov_b32 v10, v6
    v_mov_b32 v11, 0
    v_mov_b32 v12, 0
    v_mov_b32 v14, 0
    v_mov_b32 v15, 0
    v_mov_b32 v16, 0
    v_mov_b32 v17, 0
    v_mov_b32 v18, 0
    s_cmp_ge_u32 s31, 4
    s_cbranch_scc1 L_pub_done
    s_cmp_eq_u32 s29, 7
    s_cbranch_scc1 L_pub_done
    s_lshr_b32 s36, s31, 1
    s_mul_i32 s37, s36, 26624
    s_mul_i32 s34, s31, 13312
    s_add_u32 s37, s37, s34
    s_add_u32 s37, s37, 26624
    v_add_u32 v20, s37, v9
    s_mul_i32 s35, s32, 53248
    s_add_u32 s35, s35, s34
    s_cmp_eq_u32 s28, 1
    s_cbranch_scc1 L_pub_all
    s_and_b32 s36, s31, 1
    s_cmp_eq_u32 s36, 0
    s_cbranch_scc1 L_pub_done
    s_branch L_pub_b2
L_pub_all:
    ds_read_b128 v[36:39], v20 offset:0
    ds_read_b128 v[40:43], v20 offset:1024
    ds_read_b128 v[44:47], v20 offset:2048
    ds_read_b128 v[48:51], v20 offset:3072
    ds_read_b128 v[52:55], v20 offset:4096
    ds_read_b128 v[56:59], v20 offset:5120
    ds_read_b128 v[60:63], v20 offset:6144
    ds_read_b128 v[64:67], v20 offset:7168
    ds_read_b128 v[68:71], v20 offset:8192
    s_add_u32 s36, s35, 0
    s_waitcnt lgkmcnt(8)
    buffer_store_dwordx4 v[36:39], v9, s[20:23], s36 offen offset:0 sc1
    s_waitcnt lgkmcnt(7)
    buffer_store_dwordx4 v[40:43], v9, s[20:23], s36 offen offset:1024 sc1
    s_waitcnt lgkmcnt(6)
    buffer_store_dwordx4 v[44:47], v9, s[20:23], s36 offen offset:2048 sc1
    s_waitcnt lgkmcnt(5)
    buffer_store_dwordx4 v[48:51], v9, s[20:23], s36 offen offset:3072 sc1
    s_add_u32 s36, s35, 4096
    s_waitcnt lgkmcnt(4)
    buffer_store_dwordx4 v[52:55], v9, s[20:23], s36 offen offset:0 sc1
    s_waitcnt lgkmcnt(3)
    buffer_store_dwordx4 v[56:59], v9, s[20:23], s36 offen offset:1024 sc1
    s_waitcnt lgkmcnt(2)
    buffer_store_dwordx4 v[60:63], v9, s[20:23], s36 offen offset:2048 sc1
    s_waitcnt lgkmcnt(1)
    buffer_store_dwordx4 v[64:67], v9, s[20:23], s36 offen offset:3072 sc1
    s_add_u32 s36, s35, 8192
    s_waitcnt lgkmcnt(0)
    buffer_store_dwordx4 v[68:71], v9, s[20:23], s36 offen offset:0 sc1
L_pub_b2:
    ds_read_b128 v[84:87], v20 offset:9216
    ds_read_b128 v[88:91], v20 offset:10240
    ds_read_b128 v[92:95], v20 offset:11264
    ds_read_b128 v[96:99], v20 offset:12288
    s_add_u32 s36, s35, 9216
    s_waitcnt lgkmcnt(3)
    buffer_store_dwordx4 v[84:87], v9, s[20:23], s36 offen offset:0 sc1
    s_waitcnt lgkmcnt(2)
    buffer_store_dwordx4 v[88:91], v9, s[20:23], s36 offen offset:1024 sc1
    s_waitcnt lgkmcnt(1)
    buffer_store_dwordx4 v[92:95], v9, s[20:23], s36 offen offset:2048 sc1
    s_waitcnt lgkmcnt(0)
    buffer_store_dwordx4 v[96:99], v9, s[20:23], s36 offen offset:3072 sc1
L_pub_done:
    s_waitcnt lgkmcnt(0)
    v_readfirstlane_b32 s48, v4
    v_readfirstlane_b32 s49, v5
    v_cmp_gt_u32 vcc, 32, v1
    s_nop 1
    v_cndmask_b32 v28, 0, v28, vcc
    v_cndmask_b32 v29, 0, v29, vcc
    v_cndmask_b32 v34, 0, v34, vcc
    v_cndmask_b32 v35, 0, v35, vcc
    v_lshlrev_b32 v20, 2, v3
    v_sub_u32 v20, v2, v20
    v_mov_b32 v23, 0xf149f2ca
    s_cmp_eq_u32 s28, 0
    s_cbranch_scc1 L_maskA
    v_cmp_le_i32 s[36:37], 0, v20
    v_cmp_le_i32 s[38:39], 1, v20
    v_cmp_le_i32 s[40:41], 2, v20
    v_cmp_le_i32 s[42:43], 3, v20
    v_cndmask_b32 v36, v23, 0, s[36:37]
    v_cndmask_b32 v37, v23, 0, s[38:39]
    v_cndmask_b32 v38, v23, 0, s[40:41]
    v_cndmask_b32 v39, v23, 0, s[42:43]
    v_cmp_le_i32 s[36:37], 8, v20
    v_cmp_le_i32 s[38:39], 9, v20
    v_cmp_le_i32 s[40:41], 10, v20
    v_cmp_le_i32 s[42:43], 11, v20
    v_cndmask_b32 v40, v23, 0, s[36:37]
    v_cndmask_b32 v41, v23, 0, s[38:39]
    v_cndmask_b32 v42, v23, 0, s[40:41]
    v_cndmask_b32 v43, v23, 0, s[42:43]
    v_cmp_le_i32 s[36:37], 16, v20
    v_cmp_le_i32 s[38:39], 17, v20
    v_cmp_le_i32 s[40:41], 18, v20
    v_cmp_le_i32 s[42:43], 19, v20
    v_cndmask_b32 v44, v23, 0, s[36:37]
    v_cndmask_b32 v45, v23, 0, s[38:39]
    v_cndmask_b32 v46, v23, 0, s[40:41]
    v_cndmask_b32 v47, v23, 0, s[42:43]
    v_cmp_le_i32 s[36:37], 24, v20
    v_cmp_le_i32 s[38:39], 25, v20
    v_cmp_le_i32 s[40:41], 26, v20
    v_cmp_le_i32 s[42:43], 27, v20
    v_cndmask_b32 v48, v23, 0, s[36:37]
    v_cndmask_b32 v49, v23, 0, s[38:39]
    v_cndmask_b32 v50, v23, 0, s[40:41]
    v_cndmask_b32 v51, v23, 0, s[42:43]
L_mask_done:
    s_nop 1
    v_mfma_f32_32x32x16_bf16 v[68:83], v[132:135], v[24:27], v[36:51]
    v_mfma_f32_32x32x8_bf16 v[68:83], v[136:137], v[28:29], v[68:83]
    v_mfma_f32_32x32x16_bf16 v[84:99], v[138:141], v[30:33], v[36:51]
    v_mfma_f32_32x32x8_bf16 v[84:99], v[142:143], v[34:35], v[84:99]
    ds_read_b128 a[0:3], v8 offset:1536
    ds_read_b128 a[4:7], v8 offset:1568
    ds_read_b128 a[8:11], v8 offset:54784
    ds_read_b128 a[12:15], v8 offset:54816
    v_mov_b32 v144, 0
    v_mov_b32 v145, 0
    s_nop 1
    v_mfma_f32_32x32x8_bf16 v[100:115], v[144:145], v[144:145], 0
    v_mfma_f32_32x32x8_bf16 v[116:131], v[144:145], v[144:145], 0
    v_cmp_gt_u32 vcc, 32, v1
    s_mov_b32 s33, 0xffff0000
    v_max_f32 v4, v68, v69
    v_max3_f32 v4, v70, v71, v4
    v_max3_f32 v4, v72, v73, v4
    v_max3_f32 v4, v74, v75, v4
    v_max3_f32 v4, v76, v77, v4
    v_max3_f32 v4, v78, v79, v4
    v_max3_f32 v4, v80, v81, v4
    v_max3_f32 v4, v82, v83, v4
    v_mov_b32 v20, v4
    s_nop 1
    v_permlane32_swap_b32 v20, v4
    v_max_f32 v20, v20, v4
    v_sub_f32 v20, 0, v20
    v_and_b32 v21, s33, v20
    v_sub_f32 v20, v20, v21
    v_and_b32 v22, s33, v20
    v_sub_f32 v20, v20, v22
    v_lshrrev_b32 v21, 16, v21
    v_or_b32 v21, v21, v22
    v_lshrrev_b32 v20, 16, v20
    v_cndmask_b32 v28, v21, v28, vcc
    v_cndmask_b32 v29, v20, v29, vcc
    v_mfma_f32_32x32x16_bf16 v[68:83], v[132:135], v[24:27], v[36:51]
    s_nop 0
    v_mfma_f32_32x32x8_bf16 v[68:83], v[136:137], v[28:29], v[68:83]
    v_max_f32 v5, v84, v85
    v_max3_f32 v5, v86, v87, v5
    v_max3_f32 v5, v88, v89, v5
    v_max3_f32 v5, v90, v91, v5
    v_max3_f32 v5, v92, v93, v5
    v_max3_f32 v5, v94, v95, v5
    v_max3_f32 v5, v96, v97, v5
    v_max3_f32 v5, v98, v99, v5
    v_mov_b32 v20, v5
    s_nop 1
    v_permlane32_swap_b32 v20, v5
    v_max_f32 v20, v20, v5
    v_sub_f32 v20, 0, v20
    v_and_b32 v21, s33, v20
    v_sub_f32 v20, v20, v21
    v_and_b32 v22, s33, v20
    v_sub_f32 v20, v20, v22
    v_lshrrev_b32 v21, 16, v21
    v_or_b32 v21, v21, v22
    v_lshrrev_b32 v20, 16, v20
    v_cndmask_b32 v34, v21, v34, vcc
    v_cndmask_b32 v35, v20, v35, vcc
    v_mfma_f32_32x32x16_bf16 v[84:99], v[138:141], v[30:33], v[36:51]
    s_nop 0
    v_mfma_f32_32x32x8_bf16 v[84:99], v[142:143], v[34:35], v[84:99]
    v_subrev_u32 v6, 3328, v6
    v_subrev_u32 v7, 3328, v7
    v_subrev_u32 v8, 3328, v8
    s_nop 7
    s_nop 3
    v_exp_f32 v68, v68
    v_exp_f32 v69, v69
    v_exp_f32 v70, v70
    v_exp_f32 v71, v71
    v_exp_f32 v72, v72
    v_exp_f32 v73, v73
    v_exp_f32 v74, v74
    v_exp_f32 v75, v75
    v_exp_f32 v76, v76
    v_exp_f32 v77, v77
    v_cvt_pk_bf16_f32 v144, v68, v69
    v_cvt_pk_bf16_f32 v145, v70, v71
    v_cvt_pk_bf16_f32 v146, v72, v73
    v_cvt_pk_bf16_f32 v147, v74, v75
    v_exp_f32 v78, v78
    v_exp_f32 v79, v79
    v_exp_f32 v80, v80
    v_exp_f32 v81, v81
    v_exp_f32 v82, v82
    v_exp_f32 v83, v83
    v_cvt_pk_bf16_f32 v148, v76, v77
    v_cvt_pk_bf16_f32 v149, v78, v79
    v_cvt_pk_bf16_f32 v150, v80, v81
    v_cvt_pk_bf16_f32 v151, v82, v83
    s_cmp_ge_u32 s31, 4
    s_cbranch_scc1 L_nf1
    s_lshl_b32 s33, s32, 2
    s_add_u32 s33, s33, s31
    s_lshl_b32 s33, s33, 7
    s_add_u32 s33, s33, 25165824
    s_waitcnt vmcnt(0)
    s_mov_b64 exec, 0xffff
    v_mov_b32 v4, s48
    v_mov_b32 v5, s49
    v_lshlrev_b32 v20, 3, v1
    buffer_store_dwordx2 v[4:5], v20, s[20:23], s33 offen sc1
L_nf1:
    s_mov_b64 exec, -1
    s_mov_b32 s56, 0
    s_cmp_eq_u32 s28, 0
    s_cselect_b32 s54, 0, s50
    s_cselect_b32 s55, s50, 0
L_loop:
    s_cmp_eq_u32 s54, 0
    s_cbranch_scc1 L_chkf
L_loop2:
    ds_read_b128 v[132:135], v6 offset:0
    ds_read_b64 v[136:137], v7 offset:32
    ds_read_b128 v[138:141], v6 offset:53248
    ds_read_b64 v[142:143], v7 offset:53280
    s_waitcnt lgkmcnt(4)
    v_mfma_f32_32x32x16_bf16 v[100:115], a[0:3], v[144:147], v[100:115]
    v_exp_f32 v84, v84
    v_exp_f32 v85, v85
    v_exp_f32 v86, v86
    v_exp_f32 v87, v87
    v_mfma_f32_32x32x16_bf16 v[100:115], a[4:7], v[148:151], v[100:115]
    v_exp_f32 v88, v88
    v_exp_f32 v89, v89
    v_exp_f32 v90, v90
    v_exp_f32 v91, v91
    s_waitcnt lgkmcnt(0)
    v_mfma_f32_32x32x16_bf16 v[68:83], v[132:135], v[24:27], 0
    ds_read_b128 a[0:3], v8 offset:1536
    ds_read_b128 a[4:7], v8 offset:1568
    v_exp_f32 v92, v92
    v_exp_f32 v93, v93
    v_cvt_pk_bf16_f32 v152, v84, v85
    v_cvt_pk_bf16_f32 v153, v86, v87
    v_cvt_pk_bf16_f32 v154, v88, v89
    v_cvt_pk_bf16_f32 v155, v90, v91
    v_mfma_f32_32x32x8_bf16 v[68:83], v[136:137], v[28:29], v[68:83]
    v_exp_f32 v94, v94
    v_exp_f32 v95, v95
    v_exp_f32 v96, v96
    v_exp_f32 v97, v97
    v_exp_f32 v98, v98
    v_exp_f32 v99, v99
    v_cvt_pk_bf16_f32 v156, v92, v93
    v_cvt_pk_bf16_f32 v157, v94, v95
    v_cvt_pk_bf16_f32 v158, v96, v97
    v_cvt_pk_bf16_f32 v159, v98, v99
    v_mfma_f32_32x32x16_bf16 v[116:131], a[8:11], v[152:155], v[116:131]
    s_nop 0
    v_exp_f32 v68, v68
    v_exp_f32 v69, v69
    v_exp_f32 v70, v70
    v_exp_f32 v71, v71
    v_mfma_f32_32x32x16_bf16 v[116:131], a[12:15], v[156:159], v[116:131]
    v_exp_f32 v72, v72
    v_exp_f32 v73, v73
    v_exp_f32 v74, v74
    v_exp_f32 v75, v75
    v_mfma_f32_32x32x16_bf16 v[84:99], v[138:141], v[30:33], 0
    ds_read_b128 a[8:11], v8 offset:54784
    ds_read_b128 a[12:15], v8 offset:54816
    v_exp_f32 v76, v76
    v_exp_f32 v77, v77
    v_cvt_pk_bf16_f32 v144, v68, v69
    v_cvt_pk_bf16_f32 v145, v70, v71
    v_cvt_pk_bf16_f32 v146, v72, v73
    v_cvt_pk_bf16_f32 v147, v74, v75
    v_mfma_f32_32x32x8_bf16 v[84:99], v[142:143], v[34:35], v[84:99]
    v_exp_f32 v78, v78
    v_exp_f32 v79, v79
    v_exp_f32 v80, v80
    v_exp_f32 v81, v81
    v_exp_f32 v82, v82
    v_exp_f32 v83, v83
    v_cvt_pk_bf16_f32 v148, v76, v77
    v_cvt_pk_bf16_f32 v149, v78, v79
    v_cvt_pk_bf16_f32 v150, v80, v81
    v_cvt_pk_bf16_f32 v151, v82, v83
    v_subrev_u32 v6, 3328, v6
    v_subrev_u32 v7, 3328, v7
    v_subrev_u32 v8, 3328, v8
    s_sub_u32 s54, s54, 1
    s_cmp_lg_u32 s54, 0
    s_cbranch_scc1 L_loop2
L_chkf:
    s_cmp_eq_u32 s55, 0
    s_cbranch_scc1 L_last
    ds_read_b128 v[132:135], v6 offset:0
    ds_read_b64 v[136:137], v7 offset:32
    ds_read_b128 v[138:141], v6 offset:53248
    ds_read_b64 v[142:143], v7 offset:53280
    s_waitcnt lgkmcnt(4)
    v_mfma_f32_32x32x16_bf16 v[100:115], a[0:3], v[144:147], v[100:115]
    v_exp_f32 v84, v84
    v_exp_f32 v85, v85
    v_exp_f32 v86, v86
    v_exp_f32 v87, v87
    v_mfma_f32_32x32x16_bf16 v[100:115], a[4:7], v[148:151], v[100:115]
    v_exp_f32 v88, v88
    v_exp_f32 v89, v89
    v_exp_f32 v90, v90
    v_exp_f32 v91, v91
    s_waitcnt lgkmcnt(0)
    v_mfma_f32_32x32x16_bf16 v[68:83], v[132:135], v[24:27], v[52:67]
    ds_read_b128 a[0:3], v8 offset:1536
    ds_read_b128 a[4:7], v8 offset:1568
    v_exp_f32 v92, v92
    v_exp_f32 v93, v93
    v_cvt_pk_bf16_f32 v152, v84, v85
    v_cvt_pk_bf16_f32 v153, v86, v87
    v_cvt_pk_bf16_f32 v154, v88, v89
    v_cvt_pk_bf16_f32 v155, v90, v91
    v_mfma_f32_32x32x8_bf16 v[68:83], v[136:137], v[28:29], v[68:83]
    v_exp_f32 v94, v94
    v_exp_f32 v95, v95
    v_exp_f32 v96, v96
    v_exp_f32 v97, v97
    v_exp_f32 v98, v98
    v_exp_f32 v99, v99
    v_cvt_pk_bf16_f32 v156, v92, v93
    v_cvt_pk_bf16_f32 v157, v94, v95
    v_cvt_pk_bf16_f32 v158, v96, v97
    v_cvt_pk_bf16_f32 v159, v98, v99
    v_mfma_f32_32x32x16_bf16 v[116:131], a[8:11], v[152:155], v[116:131]
    s_nop 0
    v_exp_f32 v68, v68
    v_exp_f32 v69, v69
    v_exp_f32 v70, v70
    v_exp_f32 v71, v71
    v_mfma_f32_32x32x16_bf16 v[116:131], a[12:15], v[156:159], v[116:131]
    v_exp_f32 v72, v72
    v_exp_f32 v73, v73
    v_exp_f32 v74, v74
    v_exp_f32 v75, v75
    v_mfma_f32_32x32x16_bf16 v[84:99], v[138:141], v[30:33], v[52:67]
    ds_read_b128 a[8:11], v8 offset:54784
    ds_read_b128 a[12:15], v8 offset:54816
    v_exp_f32 v76, v76
    v_exp_f32 v77, v77
    v_cvt_pk_bf16_f32 v144, v68, v69
    v_cvt_pk_bf16_f32 v145, v70, v71
    v_cvt_pk_bf16_f32 v146, v72, v73
    v_cvt_pk_bf16_f32 v147, v74, v75
    v_mfma_f32_32x32x8_bf16 v[84:99], v[142:143], v[34:35], v[84:99]
    v_exp_f32 v78, v78
    v_exp_f32 v79, v79
    v_exp_f32 v80, v80
    v_exp_f32 v81, v81
    v_exp_f32 v82, v82
    v_exp_f32 v83, v83
    v_cvt_pk_bf16_f32 v148, v76, v77
    v_cvt_pk_bf16_f32 v149, v78, v79
    v_cvt_pk_bf16_f32 v150, v80, v81
    v_cvt_pk_bf16_f32 v151, v82, v83
    v_subrev_u32 v6, 3328, v6
    v_subrev_u32 v7, 3328, v7
    v_subrev_u32 v8, 3328, v8
L_last:
    s_waitcnt lgkmcnt(0)
    v_mfma_f32_32x32x16_bf16 v[100:115], a[0:3], v[144:147], v[100:115]
    v_exp_f32 v84, v84
    v_exp_f32 v85, v85
    v_exp_f32 v86, v86
    v_exp_f32 v87, v87
    v_mfma_f32_32x32x16_bf16 v[100:115], a[4:7], v[148:151], v[100:115]
    v_exp_f32 v88, v88
    v_exp_f32 v89, v89
    v_exp_f32 v90, v90
    v_exp_f32 v91, v91
    v_exp_f32 v92, v92
    v_exp_f32 v93, v93
    v_cvt_pk_bf16_f32 v152, v84, v85
    v_cvt_pk_bf16_f32 v153, v86, v87
    v_cvt_pk_bf16_f32 v154, v88, v89
    v_cvt_pk_bf16_f32 v155, v90, v91
    v_exp_f32 v94, v94
    v_exp_f32 v95, v95
    v_exp_f32 v96, v96
    v_exp_f32 v97, v97
    v_exp_f32 v98, v98
    v_exp_f32 v99, v99
    v_cvt_pk_bf16_f32 v156, v92, v93
    v_cvt_pk_bf16_f32 v157, v94, v95
    v_cvt_pk_bf16_f32 v158, v96, v97
    v_cvt_pk_bf16_f32 v159, v98, v99
    v_mfma_f32_32x32x16_bf16 v[116:131], a[8:11], v[152:155], v[116:131]
    s_nop 0
    v_mfma_f32_32x32x16_bf16 v[116:131], a[12:15], v[156:159], v[116:131]
    s_cmp_eq_u32 s56, 1
    s_cbranch_scc1 L_att_done
    s_cmp_eq_u32 s29, 0
    s_cbranch_scc1 L_att_done
    s_cmp_eq_u32 s28, 1
    s_cbranch_scc1 L_between
    s_cmp_lg_u32 s50, 0
    s_cbranch_scc1 L_att_done
L_between:
    s_mov_b32 s56, 1
    s_cmp_ge_u32 s31, 4
    s_cbranch_scc1 L_nowo
    s_cmp_ge_u32 s31, 2
    s_cbranch_scc1 L_nowo0
    s_mov_b32 exec_hi, 0x3ffff
    s_mov_b32 s33, 0
    buffer_load_dwordx4 a[16:19], v19, s[12:15], s33 offen
    s_mov_b32 s33, 51200
    buffer_load_dwordx4 a[20:23], v19, s[12:15], s33 offen
    s_mov_b32 s33, 102400
    buffer_load_dwordx4 a[24:27], v19, s[12:15], s33 offen
    s_mov_b32 s33, 153600
    buffer_load_dwordx4 a[28:31], v19, s[12:15], s33 offen
    s_mov_b32 s33, 204800
    buffer_load_dwordx4 a[32:35], v19, s[12:15], s33 offen
    s_mov_b32 s33, 256000
    buffer_load_dwordx4 a[36:39], v19, s[12:15], s33 offen
    s_mov_b32 s33, 307200
    buffer_load_dwordx4 a[40:43], v19, s[12:15], s33 offen
    s_mov_b32 s33, 358400
    buffer_load_dwordx4 a[44:47], v19, s[12:15], s33 offen
    s_mov_b32 s33, 409600
    buffer_load_dwordx4 a[48:51], v19, s[12:15], s33 offen
    s_mov_b32 s33, 460800
    buffer_load_dwordx4 a[52:55], v19, s[12:15], s33 offen
    s_mov_b32 s33, 512000
    buffer_load_dwordx4 a[56:59], v19, s[12:15], s33 offen
    s_mov_b32 s33, 563200
    buffer_load_dwordx4 a[60:63], v19, s[12:15], s33 offen
    s_mov_b32 s33, 614400
    buffer_load_dwordx4 a[64:67], v19, s[12:15], s33 offen
    s_mov_b32 s33, 665600
    buffer_load_dwordx4 a[68:71], v19, s[12:15], s33 offen
    s_mov_b32 s33, 716800
    buffer_load_dwordx4 a[72:75], v19, s[12:15], s33 offen
    s_mov_b32 s33, 768000
    buffer_load_dwordx4 a[76:79], v19, s[12:15], s33 offen
    s_mov_b64 exec, -1
L_nowo0:
    s_cmp_eq_u32 s29, 0
    s_cbranch_scc1 L_nb_done
    s_xor_b32 s45, s28, 1
    s_mul_i32 s33, s45, s31
    s_cmp_lg_u32 s33, 0
    s_cbranch_scc1 L_nb_done
    s_add_u32 s44, s31, s45
    s_lshl_b32 s45, s45, 8
    s_sub_u32 s34, s32, 16
    s_lshl_b32 s35, s34, 2
    s_add_u32 s35, s35, s44
    s_lshl_b32 s35, s35, 7
    s_add_u32 s35, s35, 25165824
    v_mul_u32_u24 v20, s45, v1
    s_mul_i32 s40, s34, 53248
    s_mul_i32 s36, s44, 13312
    s_add_u32 s40, s40, s36
    s_lshr_b32 s41, s44, 1
    s_mul_i32 s41, s41, 26624
    s_add_u32 s41, s41, s36
    s_mov_b32 exec_lo, 3
    s_mov_b32 exec_hi, 0
    s_mov_b32 s33, 0
L_poll1:
    buffer_load_dwordx2 v[4:5], v20, s[20:23], s35 offen sc1
    s_waitcnt vmcnt(0)
    v_cmp_ne_u64 vcc, s[48:49], v[4:5]
    s_add_u32 s33, s33, 1
    s_cmp_ge_u32 s33, 200000
    s_cbranch_scc1 L_poll1_done
    s_nop 1
    s_cbranch_vccnz L_poll1
L_poll1_done:
    s_mov_b64 exec, -1
    s_add_u32 m0, s41, 9216
    s_add_u32 s37, s40, 9216
    buffer_load_dwordx4 v9, s[20:23], s37 offen offset:0 sc1 lds
    buffer_load_dwordx4 v9, s[20:23], s37 offen offset:1024 sc1 lds
    buffer_load_dwordx4 v9, s[20:23], s37 offen offset:2048 sc1 lds
    buffer_load_dwordx4 v9, s[20:23], s37 offen offset:3072 sc1 lds
    s_cmp_eq_u32 s28, 1
    s_cbranch_scc1 L_nbB
    s_add_u32 s40, s40, 26624
    s_add_u32 s41, s41, 53248
    s_add_u32 m0, s41, 9216
    s_add_u32 s37, s40, 9216
    buffer_load_dwordx4 v9, s[20:23], s37 offen offset:0 sc1 lds
    buffer_load_dwordx4 v9, s[20:23], s37 offen offset:1024 sc1 lds
    buffer_load_dwordx4 v9, s[20:23], s37 offen offset:2048 sc1 lds
    buffer_load_dwordx4 v9, s[20:23], s37 offen offset:3072 sc1 lds
    s_branch L_nb_done
L_nbB:
    s_add_u32 m0, s41, 0
    s_add_u32 s37, s40, 0
    buffer_load_dwordx4 v9, s[20:23], s37 offen offset:0 sc1 lds
    buffer_load_dwordx4 v9, s[20:23], s37 offen offset:1024 sc1 lds
    buffer_load_dwordx4 v9, s[20:23], s37 offen offset:2048 sc1 lds
    buffer_load_dwordx4 v9, s[20:23], s37 offen offset:3072 sc1 lds
    s_add_u32 m0, s41, 4096
    s_add_u32 s37, s40, 4096
    buffer_load_dwordx4 v9, s[20:23], s37 offen offset:0 sc1 lds
    buffer_load_dwordx4 v9, s[20:23], s37 offen offset:1024 sc1 lds
    buffer_load_dwordx4 v9, s[20:23], s37 offen offset:2048 sc1 lds
    buffer_load_dwordx4 v9, s[20:23], s37 offen offset:3072 sc1 lds
    s_add_u32 m0, s41, 8192
    s_add_u32 s37, s40, 8192
    buffer_load_dwordx4 v9, s[20:23], s37 offen offset:0 sc1 lds
L_nb_done:
L_late:
    s_sub_u32 s33, 7, s31
    s_min_u32 s60, s31, s33
    s_lshr_b32 s61, s31, 2
    v_mul_u32_u24 v20, 6554, v1
    v_lshrrev_b32 v20, 16, v20
    v_mul_u32_u24 v21, 10, v20
    v_sub_u32 v21, v1, v21
    v_lshlrev_b32 v21, 4, v21
    s_mul_i32 s33, s31, 5
    v_add_u32 v20, s33, v20
    v_and_b32 v22, 3, v20
    v_mul_u32_u24 v22, 160, v22
    v_add_u32 v21, v21, v22
    v_and_b32 v20, 0x3c, v20
    s_mov_b32 s36, 0x56483120
    s_mov_b32 s37, 0x97
    v_lshrrev_b64 v[4:5], v20, s[36:37]
    v_and_b32 v20, 15, v4
    v_and_b32 v22, 1, v20
    v_bfe_u32 v23, v20, 1, 1
    v_lshl_add_u32 v22, v22, 1, v23
    v_and_b32 v23, 0x1c, v20
    v_add_u32 v22, v22, v23
    v_mul_u32_u24 v22, 640, v22
    v_add_u32 v11, v22, v21
    v_add_u32 v20, 10, v20
    v_and_b32 v22, 1, v20
    v_bfe_u32 v23, v20, 1, 1
    v_lshl_add_u32 v22, v22, 1, v23
    v_and_b32 v23, 0x1c, v20
    v_add_u32 v22, v22, v23
    v_mul_u32_u24 v22, 640, v22
    v_add_u32 v12, v22, v21
    s_and_b32 s42, s30, 1
    s_lshl_b32 s42, s42, 2
    s_add_u32 s42, s42, s60
    s_lshl_b32 s42, s42, 2
    s_lshr_b32 s42, 0x64317520, s42
    s_and_b32 s42, s42, 7
    v_lshrrev_b32 v20, 4, v1
    v_and_b32 v21, 15, v1
    v_lshlrev_b32 v21, 4, v21
    s_mul_i32 s33, s42, 2560
    v_add_u32 v21, s33, v21
    v_add_u32 v22, 0, v20
    v_mul_u32_u24 v23, 13, v22
    v_lshrrev_b32 v23, 6, v23
    v_mul_u32_u24 v23, 19200, v23
    v_lshl_add_u32 v22, v22, 8, v21
    v_add_u32 v14, v22, v23
    v_add_u32 v22, 4, v20
    v_mul_u32_u24 v23, 13, v22
    v_lshrrev_b32 v23, 6, v23
    v_mul_u32_u24 v23, 19200, v23
    v_lshl_add_u32 v22, v22, 8, v21
    v_add_u32 v15, v22, v23
    v_add_u32 v22, 8, v20
    v_mul_u32_u24 v23, 13, v22
    v_lshrrev_b32 v23, 6, v23
    v_mul_u32_u24 v23, 19200, v23
    v_lshl_add_u32 v22, v22, 8, v21
    v_add_u32 v16, v22, v23
    v_add_u32 v22, 12, v20
    v_mul_u32_u24 v23, 13, v22
    v_lshrrev_b32 v23, 6, v23
    v_mul_u32_u24 v23, 19200, v23
    v_lshl_add_u32 v22, v22, 8, v21
    v_add_u32 v17, v22, v23
    v_add_u32 v22, 16, v20
    v_mul_u32_u24 v23, 13, v22
    v_lshrrev_b32 v23, 6, v23
    v_mul_u32_u24 v23, 19200, v23
    v_lshl_add_u32 v22, v22, 8, v21
    v_add_u32 v18, v22, v23
    s_cmp_eq_u32 s28, 0
    s_cbranch_scc1 L_nomf
    v_xor_b32 v52, 0xf149f2ca, v36
    v_xor_b32 v53, 0xf149f2ca, v37
    v_xor_b32 v54, 0xf149f2ca, v38
    v_xor_b32 v55, 0xf149f2ca, v39
    v_xor_b32 v56, 0xf149f2ca, v40
    v_xor_b32 v57, 0xf149f2ca, v41
    v_xor_b32 v58, 0xf149f2ca, v42
    v_xor_b32 v59, 0xf149f2ca, v43
    v_xor_b32 v60, 0xf149f2ca, v44
    v_xor_b32 v61, 0xf149f2ca, v45
    v_xor_b32 v62, 0xf149f2ca, v46
    v_xor_b32 v63, 0xf149f2ca, v47
    v_xor_b32 v64, 0xf149f2ca, v48
    v_xor_b32 v65, 0xf149f2ca, v49
    v_xor_b32 v66, 0xf149f2ca, v50
    v_xor_b32 v67, 0xf149f2ca, v51
L_nomf:
    s_cmp_ge_u32 s31, 4
    s_cbranch_scc1 L_late_ret
L_nowo:
    s_cmp_eq_u32 s28, 1
    s_cbranch_scc1 L_b3b
    s_cmp_lg_u32 s31, 0
    s_cbranch_scc1 L_b3x
    s_waitcnt vmcnt(0)
    s_branch L_b3x
L_b3b:
    s_waitcnt vmcnt(0)
    s_barrier
L_b3x:
    s_cmp_ge_u32 s31, 4
    s_cbranch_scc1 L_late
L_late_ret:
    s_cmp_lt_u32 s31, 2
    s_cbranch_scc1 L_nowo2
    s_cmp_ge_u32 s31, 4
    s_cbranch_scc1 L_nowo2
    s_mov_b32 exec_hi, 0x3ffff
    s_mov_b32 s33, 0
    buffer_load_dwordx4 a[16:19], v19, s[12:15], s33 offen
    s_mov_b32 s33, 51200
    buffer_load_dwordx4 a[20:23], v19, s[12:15], s33 offen
    s_mov_b32 s33, 102400
    buffer_load_dwordx4 a[24:27], v19, s[12:15], s33 offen
    s_mov_b32 s33, 153600
    buffer_load_dwordx4 a[28:31], v19, s[12:15], s33 offen
    s_mov_b32 s33, 204800
    buffer_load_dwordx4 a[32:35], v19, s[12:15], s33 offen
    s_mov_b32 s33, 256000
    buffer_load_dwordx4 a[36:39], v19, s[12:15], s33 offen
    s_mov_b32 s33, 307200
    buffer_load_dwordx4 a[40:43], v19, s[12:15], s33 offen
    s_mov_b32 s33, 358400
    buffer_load_dwordx4 a[44:47], v19, s[12:15], s33 offen
    s_mov_b32 s33, 409600
    buffer_load_dwordx4 a[48:51], v19, s[12:15], s33 offen
    s_mov_b32 s33, 460800
    buffer_load_dwordx4 a[52:55], v19, s[12:15], s33 offen
    s_mov_b32 s33, 512000
    buffer_load_dwordx4 a[56:59], v19, s[12:15], s33 offen
    s_mov_b32 s33, 563200
    buffer_load_dwordx4 a[60:63], v19, s[12:15], s33 offen
    s_mov_b32 s33, 614400
    buffer_load_dwordx4 a[64:67], v19, s[12:15], s33 offen
    s_mov_b32 s33, 665600
    buffer_load_dwordx4 a[68:71], v19, s[12:15], s33 offen
    s_mov_b32 s33, 716800
    buffer_load_dwordx4 a[72:75], v19, s[12:15], s33 offen
    s_mov_b32 s33, 768000
    buffer_load_dwordx4 a[76:79], v19, s[12:15], s33 offen
    s_mov_b64 exec, -1
L_nowo2:
    s_min_u32 s33, s29, 1
    s_cmp_eq_u32 s50, 0
    s_cselect_b32 s34, s33, 0
    s_sub_u32 s35, 7, s50
    s_cmp_eq_u32 s28, 0
    s_cselect_b32 s54, 0, s35
    s_cselect_b32 s55, s34, s33
    s_cmp_eq_u32 s55, 0
    s_cbranch_scc1 L_pre4
    s_cmp_eq_u32 s54, 0
    s_cbranch_scc1 L_startf
    ds_read_b128 v[132:135], v6 offset:0
    ds_read_b64 v[136:137], v7 offset:32
    ds_read_b128 v[138:141], v6 offset:53248
    ds_read_b64 v[142:143], v7 offset:53280
    ds_read_b128 a[0:3], v8 offset:1536
    ds_read_b128 a[4:7], v8 offset:1568
    ds_read_b128 a[8:11], v8 offset:54784
    ds_read_b128 a[12:15], v8 offset:54816
    v_subrev_u32 v6, 3328, v6
    v_subrev_u32 v7, 3328, v7
    v_subrev_u32 v8, 3328, v8
    s_waitcnt lgkmcnt(6)
    v_mfma_f32_32x32x16_bf16 v[68:83], v[132:135], v[24:27], 0
    v_mfma_f32_32x32x8_bf16 v[68:83], v[136:137], v[28:29], v[68:83]
    s_waitcnt lgkmcnt(4)
    v_mfma_f32_32x32x16_bf16 v[84:99], v[138:141], v[30:33], 0
    v_mfma_f32_32x32x8_bf16 v[84:99], v[142:143], v[34:35], v[84:99]
    s_nop 7
    s_nop 3
    v_exp_f32 v68, v68
    v_exp_f32 v69, v69
    v_exp_f32 v70, v70
    v_exp_f32 v71, v71
    v_exp_f32 v72, v72
    v_exp_f32 v73, v73
    v_exp_f32 v74, v74
    v_exp_f32 v75, v75
    v_exp_f32 v76, v76
    v_exp_f32 v77, v77
    v_cvt_pk_bf16_f32 v144, v68, v69
    v_cvt_pk_bf16_f32 v145, v70, v71
    v_cvt_pk_bf16_f32 v146, v72, v73
    v_cvt_pk_bf16_f32 v147, v74, v75
    v_exp_f32 v78, v78
    v_exp_f32 v79, v79
    v_exp_f32 v80, v80
    v_exp_f32 v81, v81
    v_exp_f32 v82, v82
    v_exp_f32 v83, v83
    v_cvt_pk_bf16_f32 v148, v76, v77
    v_cvt_pk_bf16_f32 v149, v78, v79
    v_cvt_pk_bf16_f32 v150, v80, v81
    v_cvt_pk_bf16_f32 v151, v82, v83
    s_sub_u32 s54, s54, 1
    s_branch L_loop
L_startf:
    ds_read_b128 v[132:135], v6 offset:0
    ds_read_b64 v[136:137], v7 offset:32
    ds_read_b128 v[138:141], v6 offset:53248
    ds_read_b64 v[142:143], v7 offset:53280
    ds_read_b128 a[0:3], v8 offset:1536
    ds_read_b128 a[4:7], v8 offset:1568
    ds_read_b128 a[8:11], v8 offset:54784
    ds_read_b128 a[12:15], v8 offset:54816
    v_subrev_u32 v6, 3328, v6
    v_subrev_u32 v7, 3328, v7
    v_subrev_u32 v8, 3328, v8
    s_waitcnt lgkmcnt(6)
    v_mfma_f32_32x32x16_bf16 v[68:83], v[132:135], v[24:27], v[52:67]
    v_mfma_f32_32x32x8_bf16 v[68:83], v[136:137], v[28:29], v[68:83]
    s_waitcnt lgkmcnt(4)
    v_mfma_f32_32x32x16_bf16 v[84:99], v[138:141], v[30:33], v[52:67]
    v_mfma_f32_32x32x8_bf16 v[84:99], v[142:143], v[34:35], v[84:99]
    s_nop 7
    s_nop 3
    v_exp_f32 v68, v68
    v_exp_f32 v69, v69
    v_exp_f32 v70, v70
    v_exp_f32 v71, v71
    v_exp_f32 v72, v72
    v_exp_f32 v73, v73
    v_exp_f32 v74, v74
    v_exp_f32 v75, v75
    v_exp_f32 v76, v76
    v_exp_f32 v77, v77
    v_cvt_pk_bf16_f32 v144, v68, v69
    v_cvt_pk_bf16_f32 v145, v70, v71
    v_cvt_pk_bf16_f32 v146, v72, v73
    v_cvt_pk_bf16_f32 v147, v74, v75
    v_exp_f32 v78, v78
    v_exp_f32 v79, v79
    v_exp_f32 v80, v80
    v_exp_f32 v81, v81
    v_exp_f32 v82, v82
    v_exp_f32 v83, v83
    v_cvt_pk_bf16_f32 v148, v76, v77
    v_cvt_pk_bf16_f32 v149, v78, v79
    v_cvt_pk_bf16_f32 v150, v80, v81
    v_cvt_pk_bf16_f32 v151, v82, v83
    s_branch L_last
L_att_done:
    s_mul_i32 s33, s32, 20480
    s_mul_i32 s34, s50, 2560
    s_add_u32 s33, s33, s34
    s_add_u32 s40, s33, 16777216
    s_lshl_b32 s41, s32, 3
    s_add_u32 s41, s41, s50
    s_lshl_b32 s41, s41, 7
    s_add_u32 s41, s41, 26214400
    s_nop 3
    v_add_f32 v21, v112, v128
    v_max3_f32 v22, abs(v100), abs(v101), abs(v116)
    v_max3_f32 v22, abs(v102), abs(v103), v22
    v_max3_f32 v22, abs(v104), abs(v105), v22
    v_max3_f32 v22, abs(v106), abs(v107), v22
    v_max3_f32 v22, abs(v108), abs(v109), v22
    v_max3_f32 v22, abs(v110), abs(v111), v22
    v_max3_f32 v22, abs(v117), abs(v118), v22
    v_max3_f32 v22, abs(v119), abs(v120), v22
    v_max3_f32 v22, abs(v121), abs(v122), v22
    v_max3_f32 v22, abs(v123), abs(v124), v22
    v_max3_f32 v22, abs(v125), abs(v126), v22
    v_max3_f32 v22, abs(v127), abs(v127), v22
    v_mul_f32 v22, 0x12800000, v22
    v_add_f32 v21, v21, v22
    v_mov_b32 v23, 0x4e800000
    v_cmp_nlt_f32 vcc, v21, v23
    s_nop 4
    s_cbranch_vccnz L_fallback
L_fb_ret:
    v_lshrrev_b32 v20, 4, v2
    v_mul_u32_u24 v20, 1280, v20
    v_and_b32 v21, 15, v2
    v_lshl_add_u32 v20, v21, 4, v20
    v_lshl_add_u32 v21, v3, 8, v20
    v_rcp_f32 v22, v112
    s_nop 0
    v_mul_f32 v100, v22, v100
    v_mul_f32 v101, v22, v101
    v_mul_f32 v102, v22, v102
    v_mul_f32 v103, v22, v103
    v_mul_f32 v104, v22, v104
    v_mul_f32 v105, v22, v105
    v_mul_f32 v106, v22, v106
    v_mul_f32 v107, v22, v107
    v_mul_f32 v108, v22, v108
    v_mul_f32 v109, v22, v109
    v_mul_f32 v110, v22, v110
    v_mul_f32 v111, v22, v111
    v_cvt_pk_bf16_f32 v144, v100, v101
    v_cvt_pk_bf16_f32 v145, v102, v103
    v_cvt_pk_bf16_f32 v146, v104, v105
    v_cvt_pk_bf16_f32 v147, v106, v107
    v_cvt_pk_bf16_f32 v68, v108, v109
    v_cvt_pk_bf16_f32 v69, v110, v111
    buffer_store_dwordx4 v[144:147], v21, s[20:23], s40 offen offset:0 sc1
    v_rcp_f32 v22, v128
    s_nop 0
    v_mul_f32 v116, v22, v116
    v_mul_f32 v117, v22, v117
    v_mul_f32 v118, v22, v118
    v_mul_f32 v119, v22, v119
    v_mul_f32 v120, v22, v120
    v_mul_f32 v121, v22, v121
    v_mul_f32 v122, v22, v122
    v_mul_f32 v123, v22, v123
    v_mul_f32 v124, v22, v124
    v_mul_f32 v125, v22, v125
    v_mul_f32 v126, v22, v126
    v_mul_f32 v127, v22, v127
    v_cvt_pk_bf16_f32 v152, v116, v117
    v_cvt_pk_bf16_f32 v153, v118, v119
    v_cvt_pk_bf16_f32 v154, v120, v121
    v_cvt_pk_bf16_f32 v155, v122, v123
    v_cvt_pk_bf16_f32 v70, v124, v125
    v_cvt_pk_bf16_f32 v71, v126, v127
    buffer_store_dwordx4 v[152:155], v21, s[20:23], s40 offen offset:512 sc1
    s_mov_b32 exec_hi, 0
    buffer_store_dwordx4 v[68:71], v20, s[20:23], s40 offen offset:1024 sc1
    s_mov_b64 exec, -1
    v_min_u32 v23, 19, v1
    v_lshlrev_b32 v23, 7, v23
    v_mov_b32 v4, s48
    v_mov_b32 v5, s49
    v_lshlrev_b32 v20, 3, v1
    s_mov_b32 s43, 0
    s_waitcnt vmcnt(0)
    s_mov_b64 exec, 0xffff
    buffer_store_dwordx2 v[4:5], v20, s[20:23], s41 offen sc1
    s_mov_b64 exec, -1
    buffer_load_dword v0, v23, s[20:23], s40 offen sc1
    s_cmp_eq_u32 s56, 0
    s_cbranch_scc1 L_between
    s_branch L_b4
L_pre4:
    s_mov_b32 s43, 0
    s_waitcnt vmcnt(0)
L_b4:
    s_mov_b32 exec_hi, 0x3ffff
    v_add_u32 v144, 106496, v11
    v_add_u32 v145, 106496, v12
    ds_write_b128 v144, a[48:51] offset:0
    ds_write_b128 v145, a[52:55] offset:0
    ds_write_b128 v144, a[56:59] offset:12800
    ds_write_b128 v145, a[60:63] offset:12800
    ds_write_b128 v144, a[64:67] offset:25600
    ds_write_b128 v145, a[68:71] offset:25600
    ds_write_b128 v144, a[72:75] offset:38400
    ds_write_b128 v145, a[76:79] offset:38400
    s_barrier
    ds_write_b128 v11, a[16:19] offset:0
    ds_write_b128 v12, a[20:23] offset:0
    ds_write_b128 v11, a[24:27] offset:12800
    ds_write_b128 v12, a[28:31] offset:12800
    ds_write_b128 v11, a[32:35] offset:25600
    ds_write_b128 v12, a[36:39] offset:25600
    ds_write_b128 v11, a[40:43] offset:38400
    ds_write_b128 v12, a[44:47] offset:38400
    s_mov_b64 exec, -1
    s_and_b32 s34, s32, 0xf0
    s_lshl_b32 s35, s61, 3
    s_add_u32 s34, s34, s35
    s_lshl_b32 s35, s34, 3
    s_add_u32 s35, s35, s42
    s_lshl_b32 s35, s35, 7
    s_add_u32 s35, s35, 26214400
    v_lshlrev_b32 v22, 10, v1
    v_lshrrev_b32 v20, 5, v1
    v_bfe_u32 v21, v1, 4, 1
    v_lshlrev_b32 v20, 2, v20
    v_add_u32 v20, v20, v21
    v_bfe_u32 v21, v1, 2, 2
    v_lshl_add_u32 v20, v20, 2, v21
    v_mul_u32_u24 v20, 160, v20
    v_and_b32 v21, 3, v1
    v_lshl_add_u32 v20, v21, 3, v20
    s_mul_i32 s36, s61, 106496
    v_add_u32 v20, s36, v20
    s_mul_i32 s38, s34, 20480
    s_add_u32 s38, s38, 16777216
    s_add_u32 s39, s38, 81920
    s_mov_b64 exec, 0xff
    buffer_load_dwordx2 v[4:5], v22, s[20:23], s35 offen sc1
    s_mov_b64 exec, -1
    s_waitcnt lgkmcnt(0)
    s_barrier
    s_mov_b32 s43, 0
    ds_read_b64_tr_b16 a[0:1], v20 offset:0
    ds_read_b64_tr_b16 a[2:3], v20 offset:1280
    ds_read_b64_tr_b16 a[4:5], v20 offset:32
    ds_read_b64_tr_b16 a[6:7], v20 offset:1312
    ds_read_b64_tr_b16 a[8:9], v20 offset:64
    ds_read_b64_tr_b16 a[10:11], v20 offset:1344
    ds_read_b64_tr_b16 a[12:13], v20 offset:96
    ds_read_b64_tr_b16 a[14:15], v20 offset:1376
    ds_read_b64_tr_b16 a[16:17], v20 offset:128
    ds_read_b64_tr_b16 a[18:19], v20 offset:1408
    ds_read_b64_tr_b16 a[20:21], v20 offset:5120
    ds_read_b64_tr_b16 a[22:23], v20 offset:6400
    ds_read_b64_tr_b16 a[24:25], v20 offset:5152
    ds_read_b64_tr_b16 a[26:27], v20 offset:6432
    ds_read_b64_tr_b16 a[28:29], v20 offset:5184
    ds_read_b64_tr_b16 a[30:31], v20 offset:6464
    ds_read_b64_tr_b16 a[32:33], v20 offset:5216
    ds_read_b64_tr_b16 a[34:35], v20 offset:6496
    ds_read_b64_tr_b16 a[36:37], v20 offset:5248
    ds_read_b64_tr_b16 a[38:39], v20 offset:6528
    s_cmp_lg_u32 s43, 0
    s_cbranch_scc1 L_sk1
    s_waitcnt vmcnt(0)
    s_mov_b64 exec, 0xff
    v_cmp_ne_u64 vcc, s[48:49], v[4:5]
    s_nop 4
    s_cbranch_vccz L_ok1
    buffer_load_dwordx2 v[4:5], v22, s[20:23], s35 offen sc1
    s_mov_b64 exec, -1
    s_branch L_sk1
L_ok1:
    s_mov_b64 exec, -1
    buffer_load_dwordx4 v[24:27], v14, s[20:23], s38 offen offset:0 sc1
    buffer_load_dwordx4 v[28:31], v14, s[20:23], s38 offen offset:1280 sc1
    buffer_load_dwordx4 v[32:35], v15, s[20:23], s38 offen offset:0 sc1
    buffer_load_dwordx4 v[36:39], v15, s[20:23], s38 offen offset:1280 sc1
    buffer_load_dwordx4 v[40:43], v16, s[20:23], s38 offen offset:0 sc1
    buffer_load_dwordx4 v[44:47], v16, s[20:23], s38 offen offset:1280 sc1
    buffer_load_dwordx4 v[48:51], v17, s[20:23], s38 offen offset:0 sc1
    buffer_load_dwordx4 v[52:55], v17, s[20:23], s38 offen offset:1280 sc1
    buffer_load_dwordx4 v[56:59], v18, s[20:23], s38 offen offset:0 sc1
    buffer_load_dwordx4 v[60:63], v18, s[20:23], s38 offen offset:1280 sc1
    s_mov_b32 s43, 1
L_sk1:
    ds_read_b64_tr_b16 a[40:41], v20 offset:10240
    ds_read_b64_tr_b16 a[42:43], v20 offset:11520
    ds_read_b64_tr_b16 a[44:45], v20 offset:10272
    ds_read_b64_tr_b16 a[46:47], v20 offset:11552
    ds_read_b64_tr_b16 a[48:49], v20 offset:10304
    ds_read_b64_tr_b16 a[50:51], v20 offset:11584
    ds_read_b64_tr_b16 a[52:53], v20 offset:10336
    ds_read_b64_tr_b16 a[54:55], v20 offset:11616
    ds_read_b64_tr_b16 a[56:57], v20 offset:10368
    ds_read_b64_tr_b16 a[58:59], v20 offset:11648
    ds_read_b64_tr_b16 a[60:61], v20 offset:15360
    ds_read_b64_tr_b16 a[62:63], v20 offset:16640
    ds_read_b64_tr_b16 a[64:65], v20 offset:15392
    ds_read_b64_tr_b16 a[66:67], v20 offset:16672
    ds_read_b64_tr_b16 a[68:69], v20 offset:15424
    ds_read_b64_tr_b16 a[70:71], v20 offset:16704
    ds_read_b64_tr_b16 a[72:73], v20 offset:15456
    ds_read_b64_tr_b16 a[74:75], v20 offset:16736
    ds_read_b64_tr_b16 a[76:77], v20 offset:15488
    ds_read_b64_tr_b16 a[78:79], v20 offset:16768
    s_cmp_lg_u32 s43, 0
    s_cbranch_scc1 L_sk3
    s_waitcnt vmcnt(0)
    s_mov_b64 exec, 0xff
    v_cmp_ne_u64 vcc, s[48:49], v[4:5]
    s_nop 4
    s_cbranch_vccz L_ok3
    buffer_load_dwordx2 v[4:5], v22, s[20:23], s35 offen sc1
    s_mov_b64 exec, -1
    s_branch L_sk3
L_ok3:
    s_mov_b64 exec, -1
    buffer_load_dwordx4 v[24:27], v14, s[20:23], s38 offen offset:0 sc1
    buffer_load_dwordx4 v[28:31], v14, s[20:23], s38 offen offset:1280 sc1
    buffer_load_dwordx4 v[32:35], v15, s[20:23], s38 offen offset:0 sc1
    buffer_load_dwordx4 v[36:39], v15, s[20:23], s38 offen offset:1280 sc1
    buffer_load_dwordx4 v[40:43], v16, s[20:23], s38 offen offset:0 sc1
    buffer_load_dwordx4 v[44:47], v16, s[20:23], s38 offen offset:1280 sc1
    buffer_load_dwordx4 v[48:51], v17, s[20:23], s38 offen offset:0 sc1
    buffer_load_dwordx4 v[52:55], v17, s[20:23], s38 offen offset:1280 sc1
    buffer_load_dwordx4 v[56:59], v18, s[20:23], s38 offen offset:0 sc1
    buffer_load_dwordx4 v[60:63], v18, s[20:23], s38 offen offset:1280 sc1
    s_mov_b32 s43, 1
L_sk3:
    ds_read_b64_tr_b16 a[80:81], v20 offset:20480
    ds_read_b64_tr_b16 a[82:83], v20 offset:21760
    ds_read_b64_tr_b16 a[84:85], v20 offset:20512
    ds_read_b64_tr_b16 a[86:87], v20 offset:21792
    ds_read_b64_tr_b16 a[88:89], v20 offset:20544
    ds_read_b64_tr_b16 a[90:91], v20 offset:21824
    ds_read_b64_tr_b16 a[92:93], v20 offset:20576
    ds_read_b64_tr_b16 a[94:95], v20 offset:21856
    ds_read_b64_tr_b16 v[72:73], v20 offset:20608
    ds_read_b64_tr_b16 v[74:75], v20 offset:21888
    ds_read_b64_tr_b16 v[76:77], v20 offset:25600
    ds_read_b64_tr_b16 v[78:79], v20 offset:26880
    ds_read_b64_tr_b16 v[80:81], v20 offset:25632
    ds_read_b64_tr_b16 v[82:83], v20 offset:26912
    ds_read_b64_tr_b16 v[84:85], v20 offset:25664
    ds_read_b64_tr_b16 v[86:87], v20 offset:26944
    ds_read_b64_tr_b16 v[88:89], v20 offset:25696
    ds_read_b64_tr_b16 v[90:91], v20 offset:26976
    ds_read_b64_tr_b16 v[92:93], v20 offset:25728
    ds_read_b64_tr_b16 v[94:95], v20 offset:27008
    s_cmp_lg_u32 s43, 0
    s_cbranch_scc1 L_sk5
    s_waitcnt vmcnt(0)
    s_mov_b64 exec, 0xff
    v_cmp_ne_u64 vcc, s[48:49], v[4:5]
    s_nop 4
    s_cbranch_vccz L_ok5
    buffer_load_dwordx2 v[4:5], v22, s[20:23], s35 offen sc1
    s_mov_b64 exec, -1
    s_branch L_sk5
L_ok5:
    s_mov_b64 exec, -1
    buffer_load_dwordx4 v[24:27], v14, s[20:23], s38 offen offset:0 sc1
    buffer_load_dwordx4 v[28:31], v14, s[20:23], s38 offen offset:1280 sc1
    buffer_load_dwordx4 v[32:35], v15, s[20:23], s38 offen offset:0 sc1
    buffer_load_dwordx4 v[36:39], v15, s[20:23], s38 offen offset:1280 sc1
    buffer_load_dwordx4 v[40:43], v16, s[20:23], s38 offen offset:0 sc1
    buffer_load_dwordx4 v[44:47], v16, s[20:23], s38 offen offset:1280 sc1
    buffer_load_dwordx4 v[48:51], v17, s[20:23], s38 offen offset:0 sc1
    buffer_load_dwordx4 v[52:55], v17, s[20:23], s38 offen offset:1280 sc1
    buffer_load_dwordx4 v[56:59], v18, s[20:23], s38 offen offset:0 sc1
    buffer_load_dwordx4 v[60:63], v18, s[20:23], s38 offen offset:1280 sc1
    s_mov_b32 s43, 1
L_sk5:
    ds_read_b64_tr_b16 v[96:97], v20 offset:30720
    ds_read_b64_tr_b16 v[98:99], v20 offset:32000
    ds_read_b64_tr_b16 v[100:101], v20 offset:30752
    ds_read_b64_tr_b16 v[102:103], v20 offset:32032
    ds_read_b64_tr_b16 v[144:145], v20 offset:30784
    ds_read_b64_tr_b16 v[146:147], v20 offset:32064
    ds_read_b64_tr_b16 v[148:149], v20 offset:30816
    ds_read_b64_tr_b16 v[150:151], v20 offset:32096
    ds_read_b64_tr_b16 v[152:153], v20 offset:30848
    ds_read_b64_tr_b16 v[154:155], v20 offset:32128
    s_cmp_lg_u32 s43, 0
    s_cbranch_scc1 L_p3go
    s_mov_b32 exec_lo, 255
    s_mov_b32 exec_hi, 0
    s_mov_b32 s33, 0
L_poll2:
    buffer_load_dwordx2 v[4:5], v22, s[20:23], s35 offen sc1
    s_waitcnt vmcnt(0)
    v_cmp_ne_u64 vcc, s[48:49], v[4:5]
    s_add_u32 s33, s33, 1
    s_cmp_ge_u32 s33, 200000
    s_cbranch_scc1 L_poll2_done
    s_nop 1
    s_cbranch_vccnz L_poll2
L_poll2_done:
    s_mov_b64 exec, -1
    buffer_load_dwordx4 v[24:27], v14, s[20:23], s38 offen offset:0 sc1
    buffer_load_dwordx4 v[28:31], v14, s[20:23], s38 offen offset:1280 sc1
    buffer_load_dwordx4 v[32:35], v15, s[20:23], s38 offen offset:0 sc1
    buffer_load_dwordx4 v[36:39], v15, s[20:23], s38 offen offset:1280 sc1
    buffer_load_dwordx4 v[40:43], v16, s[20:23], s38 offen offset:0 sc1
    buffer_load_dwordx4 v[44:47], v16, s[20:23], s38 offen offset:1280 sc1
    buffer_load_dwordx4 v[48:51], v17, s[20:23], s38 offen offset:0 sc1
    buffer_load_dwordx4 v[52:55], v17, s[20:23], s38 offen offset:1280 sc1
    buffer_load_dwordx4 v[56:59], v18, s[20:23], s38 offen offset:0 sc1
    buffer_load_dwordx4 v[60:63], v18, s[20:23], s38 offen offset:1280 sc1
L_p3go:
    buffer_load_dwordx4 v[64:67], v14, s[20:23], s39 offen offset:0 sc1
    buffer_load_dwordx4 v[68:71], v14, s[20:23], s39 offen offset:1280 sc1
    s_waitcnt vmcnt(10) lgkmcnt(0)
    v_mfma_f32_16x16x32_bf16 v[104:107], a[0:3], v[24:27], 0
    v_mfma_f32_16x16x32_bf16 v[124:127], a[0:3], v[28:31], 0
    v_mfma_f32_16x16x32_bf16 v[108:111], a[4:7], v[24:27], 0
    v_mfma_f32_16x16x32_bf16 v[128:131], a[4:7], v[28:31], 0
    v_mfma_f32_16x16x32_bf16 v[112:115], a[8:11], v[24:27], 0
    v_mfma_f32_16x16x32_bf16 v[132:135], a[8:11], v[28:31], 0
    v_mfma_f32_16x16x32_bf16 v[116:119], a[12:15], v[24:27], 0
    v_mfma_f32_16x16x32_bf16 v[136:139], a[12:15], v[28:31], 0
    v_mfma_f32_16x16x32_bf16 v[120:123], a[16:19], v[24:27], 0
    v_mfma_f32_16x16x32_bf16 v[140:143], a[16:19], v[28:31], 0
    buffer_load_dwordx4 v[24:27], v15, s[20:23], s39 offen offset:0 sc1
    buffer_load_dwordx4 v[28:31], v15, s[20:23], s39 offen offset:1280 sc1
    s_waitcnt vmcnt(10)
    v_mfma_f32_16x16x32_bf16 v[104:107], a[20:23], v[32:35], v[104:107]
    ds_read_b64_tr_b16 a[0:1], v20 offset:35840
    v_mfma_f32_16x16x32_bf16 v[124:127], a[20:23], v[36:39], v[124:127]
    ds_read_b64_tr_b16 a[2:3], v20 offset:37120
    v_mfma_f32_16x16x32_bf16 v[108:111], a[24:27], v[32:35], v[108:111]
    ds_read_b64_tr_b16 a[4:5], v20 offset:35872
    v_mfma_f32_16x16x32_bf16 v[128:131], a[24:27], v[36:39], v[128:131]
    ds_read_b64_tr_b16 a[6:7], v20 offset:37152
    v_mfma_f32_16x16x32_bf16 v[112:115], a[28:31], v[32:35], v[112:115]
    ds_read_b64_tr_b16 a[8:9], v20 offset:35904
    v_mfma_f32_16x16x32_bf16 v[132:135], a[28:31], v[36:39], v[132:135]
    ds_read_b64_tr_b16 a[10:11], v20 offset:37184
    v_mfma_f32_16x16x32_bf16 v[116:119], a[32:35], v[32:35], v[116:119]
    ds_read_b64_tr_b16 a[12:13], v20 offset:35936
    v_mfma_f32_16x16x32_bf16 v[136:139], a[32:35], v[36:39], v[136:139]
    ds_read_b64_tr_b16 a[14:15], v20 offset:37216
    v_mfma_f32_16x16x32_bf16 v[120:123], a[36:39], v[32:35], v[120:123]
    ds_read_b64_tr_b16 a[16:17], v20 offset:35968
    v_mfma_f32_16x16x32_bf16 v[140:143], a[36:39], v[36:39], v[140:143]
    ds_read_b64_tr_b16 a[18:19], v20 offset:37248
    buffer_load_dwordx4 v[32:35], v16, s[20:23], s39 offen offset:0 sc1
    buffer_load_dwordx4 v[36:39], v16, s[20:23], s39 offen offset:1280 sc1
    s_waitcnt vmcnt(10)
    v_mfma_f32_16x16x32_bf16 v[104:107], a[40:43], v[40:43], v[104:107]
    ds_read_b64_tr_b16 a[20:21], v20 offset:40960
    v_mfma_f32_16x16x32_bf16 v[124:127], a[40:43], v[44:47], v[124:127]
    ds_read_b64_tr_b16 a[22:23], v20 offset:42240
    v_mfma_f32_16x16x32_bf16 v[108:111], a[44:47], v[40:43], v[108:111]
    ds_read_b64_tr_b16 a[24:25], v20 offset:40992
    v_mfma_f32_16x16x32_bf16 v[128:131], a[44:47], v[44:47], v[128:131]
    ds_read_b64_tr_b16 a[26:27], v20 offset:42272
    v_mfma_f32_16x16x32_bf16 v[112:115], a[48:51], v[40:43], v[112:115]
    ds_read_b64_tr_b16 a[28:29], v20 offset:41024
    v_mfma_f32_16x16x32_bf16 v[132:135], a[48:51], v[44:47], v[132:135]
    ds_read_b64_tr_b16 a[30:31], v20 offset:42304
    v_mfma_f32_16x16x32_bf16 v[116:119], a[52:55], v[40:43], v[116:119]
    ds_read_b64_tr_b16 a[32:33], v20 offset:41056
    v_mfma_f32_16x16x32_bf16 v[136:139], a[52:55], v[44:47], v[136:139]
    ds_read_b64_tr_b16 a[34:35], v20 offset:42336
    v_mfma_f32_16x16x32_bf16 v[120:123], a[56:59], v[40:43], v[120:123]
    ds_read_b64_tr_b16 a[36:37], v20 offset:41088
    v_mfma_f32_16x16x32_bf16 v[140:143], a[56:59], v[44:47], v[140:143]
    ds_read_b64_tr_b16 a[38:39], v20 offset:42368
    buffer_load_dwordx4 v[40:43], v17, s[20:23], s39 offen offset:0 sc1
    buffer_load_dwordx4 v[44:47], v17, s[20:23], s39 offen offset:1280 sc1
    s_waitcnt vmcnt(10)
    v_mfma_f32_16x16x32_bf16 v[104:107], a[60:63], v[48:51], v[104:107]
    ds_read_b64_tr_b16 a[40:41], v20 offset:46080
    v_mfma_f32_16x16x32_bf16 v[124:127], a[60:63], v[52:55], v[124:127]
    ds_read_b64_tr_b16 a[42:43], v20 offset:47360
    v_mfma_f32_16x16x32_bf16 v[108:111], a[64:67], v[48:51], v[108:111]
    ds_read_b64_tr_b16 a[44:45], v20 offset:46112
    v_mfma_f32_16x16x32_bf16 v[128:131], a[64:67], v[52:55], v[128:131]
    ds_read_b64_tr_b16 a[46:47], v20 offset:47392
    v_mfma_f32_16x16x32_bf16 v[112:115], a[68:71], v[48:51], v[112:115]
    ds_read_b64_tr_b16 a[48:49], v20 offset:46144
    v_mfma_f32_16x16x32_bf16 v[132:135], a[68:71], v[52:55], v[132:135]
    ds_read_b64_tr_b16 a[50:51], v20 offset:47424
    v_mfma_f32_16x16x32_bf16 v[116:119], a[72:75], v[48:51], v[116:119]
    ds_read_b64_tr_b16 a[52:53], v20 offset:46176
    v_mfma_f32_16x16x32_bf16 v[136:139], a[72:75], v[52:55], v[136:139]
    ds_read_b64_tr_b16 a[54:55], v20 offset:47456
    v_mfma_f32_16x16x32_bf16 v[120:123], a[76:79], v[48:51], v[120:123]
    ds_read_b64_tr_b16 a[56:57], v20 offset:46208
    v_mfma_f32_16x16x32_bf16 v[140:143], a[76:79], v[52:55], v[140:143]
    ds_read_b64_tr_b16 a[58:59], v20 offset:47488
    buffer_load_dwordx4 v[48:51], v18, s[20:23], s39 offen offset:0 sc1
    buffer_load_dwordx4 v[52:55], v18, s[20:23], s39 offen offset:1280 sc1
    s_waitcnt vmcnt(10)
    v_mfma_f32_16x16x32_bf16 v[104:107], a[80:83], v[56:59], v[104:107]
    v_mfma_f32_16x16x32_bf16 v[124:127], a[80:83], v[60:63], v[124:127]
    v_mfma_f32_16x16x32_bf16 v[108:111], a[84:87], v[56:59], v[108:111]
    v_mfma_f32_16x16x32_bf16 v[128:131], a[84:87], v[60:63], v[128:131]
    v_mfma_f32_16x16x32_bf16 v[112:115], a[88:91], v[56:59], v[112:115]
    v_mfma_f32_16x16x32_bf16 v[132:135], a[88:91], v[60:63], v[132:135]
    v_mfma_f32_16x16x32_bf16 v[116:119], a[92:95], v[56:59], v[116:119]
    v_mfma_f32_16x16x32_bf16 v[136:139], a[92:95], v[60:63], v[136:139]
    v_mfma_f32_16x16x32_bf16 v[120:123], v[72:75], v[56:59], v[120:123]
    v_mfma_f32_16x16x32_bf16 v[140:143], v[72:75], v[60:63], v[140:143]
    s_waitcnt vmcnt(8)
    v_mfma_f32_16x16x32_bf16 v[104:107], v[76:79], v[64:67], v[104:107]
    v_mfma_f32_16x16x32_bf16 v[124:127], v[76:79], v[68:71], v[124:127]
    v_mfma_f32_16x16x32_bf16 v[108:111], v[80:83], v[64:67], v[108:111]
    v_mfma_f32_16x16x32_bf16 v[128:131], v[80:83], v[68:71], v[128:131]
    v_mfma_f32_16x16x32_bf16 v[112:115], v[84:87], v[64:67], v[112:115]
    v_mfma_f32_16x16x32_bf16 v[132:135], v[84:87], v[68:71], v[132:135]
    v_mfma_f32_16x16x32_bf16 v[116:119], v[88:91], v[64:67], v[116:119]
    v_mfma_f32_16x16x32_bf16 v[136:139], v[88:91], v[68:71], v[136:139]
    v_mfma_f32_16x16x32_bf16 v[120:123], v[92:95], v[64:67], v[120:123]
    v_mfma_f32_16x16x32_bf16 v[140:143], v[92:95], v[68:71], v[140:143]
    s_waitcnt vmcnt(6)
    v_mfma_f32_16x16x32_bf16 v[104:107], v[96:99], v[24:27], v[104:107]
    v_mfma_f32_16x16x32_bf16 v[124:127], v[96:99], v[28:31], v[124:127]
    v_mfma_f32_16x16x32_bf16 v[108:111], v[100:103], v[24:27], v[108:111]
    v_mfma_f32_16x16x32_bf16 v[128:131], v[100:103], v[28:31], v[128:131]
    v_mfma_f32_16x16x32_bf16 v[112:115], v[144:147], v[24:27], v[112:115]
    v_mfma_f32_16x16x32_bf16 v[132:135], v[144:147], v[28:31], v[132:135]
    v_mfma_f32_16x16x32_bf16 v[116:119], v[148:151], v[24:27], v[116:119]
    v_mfma_f32_16x16x32_bf16 v[136:139], v[148:151], v[28:31], v[136:139]
    v_mfma_f32_16x16x32_bf16 v[120:123], v[152:155], v[24:27], v[120:123]
    v_mfma_f32_16x16x32_bf16 v[140:143], v[152:155], v[28:31], v[140:143]
    s_waitcnt vmcnt(4) lgkmcnt(0)
    v_mfma_f32_16x16x32_bf16 v[104:107], a[0:3], v[32:35], v[104:107]
    v_mfma_f32_16x16x32_bf16 v[124:127], a[0:3], v[36:39], v[124:127]
    v_mfma_f32_16x16x32_bf16 v[108:111], a[4:7], v[32:35], v[108:111]
    v_mfma_f32_16x16x32_bf16 v[128:131], a[4:7], v[36:39], v[128:131]
    v_mfma_f32_16x16x32_bf16 v[112:115], a[8:11], v[32:35], v[112:115]
    v_mfma_f32_16x16x32_bf16 v[132:135], a[8:11], v[36:39], v[132:135]
    v_mfma_f32_16x16x32_bf16 v[116:119], a[12:15], v[32:35], v[116:119]
    v_mfma_f32_16x16x32_bf16 v[136:139], a[12:15], v[36:39], v[136:139]
    v_mfma_f32_16x16x32_bf16 v[120:123], a[16:19], v[32:35], v[120:123]
    v_mfma_f32_16x16x32_bf16 v[140:143], a[16:19], v[36:39], v[140:143]
    s_waitcnt vmcnt(2)
    v_mfma_f32_16x16x32_bf16 v[104:107], a[20:23], v[40:43], v[104:107]
    v_mfma_f32_16x16x32_bf16 v[124:127], a[20:23], v[44:47], v[124:127]
    v_mfma_f32_16x16x32_bf16 v[108:111], a[24:27], v[40:43], v[108:111]
    v_mfma_f32_16x16x32_bf16 v[128:131], a[24:27], v[44:47], v[128:131]
    v_mfma_f32_16x16x32_bf16 v[112:115], a[28:31], v[40:43], v[112:115]
    v_mfma_f32_16x16x32_bf16 v[132:135], a[28:31], v[44:47], v[132:135]
    v_mfma_f32_16x16x32_bf16 v[116:119], a[32:35], v[40:43], v[116:119]
    v_mfma_f32_16x16x32_bf16 v[136:139], a[32:35], v[44:47], v[136:139]
    v_mfma_f32_16x16x32_bf16 v[120:123], a[36:39], v[40:43], v[120:123]
    v_mfma_f32_16x16x32_bf16 v[140:143], a[36:39], v[44:47], v[140:143]
    s_waitcnt vmcnt(0)
    v_mfma_f32_16x16x32_bf16 v[104:107], a[40:43], v[48:51], v[104:107]
    v_mfma_f32_16x16x32_bf16 v[124:127], a[40:43], v[52:55], v[124:127]
    v_mfma_f32_16x16x32_bf16 v[108:111], a[44:47], v[48:51], v[108:111]
    v_mfma_f32_16x16x32_bf16 v[128:131], a[44:47], v[52:55], v[128:131]
    v_mfma_f32_16x16x32_bf16 v[112:115], a[48:51], v[48:51], v[112:115]
    v_mfma_f32_16x16x32_bf16 v[132:135], a[48:51], v[52:55], v[132:135]
    v_mfma_f32_16x16x32_bf16 v[116:119], a[52:55], v[48:51], v[116:119]
    v_mfma_f32_16x16x32_bf16 v[136:139], a[52:55], v[52:55], v[136:139]
    v_mfma_f32_16x16x32_bf16 v[120:123], a[56:59], v[48:51], v[120:123]
    v_mfma_f32_16x16x32_bf16 v[140:143], a[56:59], v[52:55], v[140:143]
    s_mul_i32 s33, s31, 5120
    s_add_u32 s33, s33, 51200
    v_add_u32 v20, s33, v9
    s_xor_b32 s34, s31, 7
    s_mul_i32 s34, s34, 5120
    s_add_u32 s34, s34, 51200
    v_add_u32 v21, s34, v9
    s_cmp_eq_u32 s61, 0
    s_cbranch_scc1 L_x0
    ds_write_b128 v20, v[104:107] offset:0
    ds_write_b128 v20, v[108:111] offset:1024
    ds_write_b128 v20, v[112:115] offset:2048
    ds_write_b128 v20, v[116:119] offset:3072
    ds_write_b128 v20, v[120:123] offset:4096
    s_nop 1
    v_mov_b32 v104, v124
    v_mov_b32 v105, v125
    v_mov_b32 v106, v126
    v_mov_b32 v107, v127
    v_mov_b32 v108, v128
    v_mov_b32 v109, v129
    v_mov_b32 v110, v130
    v_mov_b32 v111, v131
    v_mov_b32 v112, v132
    v_mov_b32 v113, v133
    v_mov_b32 v114, v134
    v_mov_b32 v115, v135
    v_mov_b32 v116, v136
    v_mov_b32 v117, v137
    v_mov_b32 v118, v138
    v_mov_b32 v119, v139
    v_mov_b32 v120, v140
    v_mov_b32 v121, v141
    v_mov_b32 v122, v142
    v_mov_b32 v123, v143
    s_branch L_x1
L_x0:
    s_nop 7
    ds_write_b128 v20, v[124:127] offset:0
    ds_write_b128 v20, v[128:131] offset:1024
    ds_write_b128 v20, v[132:135] offset:2048
    ds_write_b128 v20, v[136:139] offset:3072
    ds_write_b128 v20, v[140:143] offset:4096
L_x1:
    s_lshl_b32 s33, s29, 8
    s_lshl_b32 s34, s42, 5
    s_add_u32 s33, s33, s34
    s_lshl_b32 s34, s61, 4
    s_add_u32 s33, s33, s34
    s_mul_i32 s33, s33, 2560
    s_mul_i32 s34, s28, 1280
    s_add_u32 s33, s33, s34
    s_lshr_b32 s34, s30, 1
    s_mul_i32 s34, s34, 160
    s_add_u32 s33, s33, s34
    v_and_b32 v20, 15, v1
    v_mul_u32_u24 v20, 176, v20
    v_lshrrev_b32 v22, 4, v1
    v_lshl_add_u32 v20, v22, 3, v20
    s_lshl_b32 s34, s31, 12
    v_add_u32 v20, s34, v20
    v_add_u32 v22, 0, v1
    v_mul_u32_u24 v23, 6554, v22
    v_lshrrev_b32 v23, 16, v23
    v_lshlrev_b32 v22, 4, v22
    v_lshl_add_u32 v50, v23, 4, v22
    v_add_u32 v50, s34, v50
    v_mul_u32_u24 v23, 2400, v23
    v_add_u32 v53, v22, v23
    v_add_u32 v22, 64, v1
    v_mul_u32_u24 v23, 6554, v22
    v_lshrrev_b32 v23, 16, v23
    v_lshlrev_b32 v22, 4, v22
    v_lshl_add_u32 v51, v23, 4, v22
    v_add_u32 v51, s34, v51
    v_mul_u32_u24 v23, 2400, v23
    v_add_u32 v54, v22, v23
    v_add_u32 v22, 128, v1
    v_mul_u32_u24 v23, 6554, v22
    v_lshrrev_b32 v23, 16, v23
    v_lshlrev_b32 v22, 4, v22
    v_lshl_add_u32 v52, v23, 4, v22
    v_add_u32 v52, s34, v52
    v_mul_u32_u24 v23, 2400, v23
    v_add_u32 v55, v22, v23
    s_waitcnt lgkmcnt(0)
    s_barrier
    ds_read_b128 v[24:27], v21 offset:0
    ds_read_b128 v[28:31], v21 offset:1024
    ds_read_b128 v[32:35], v21 offset:2048
    ds_read_b128 v[36:39], v21 offset:3072
    ds_read_b128 v[40:43], v21 offset:4096
    s_waitcnt lgkmcnt(4)
    v_pk_add_f32 v[104:105], v[104:105], v[24:25]
    v_pk_add_f32 v[106:107], v[106:107], v[26:27]
    v_cvt_pk_bf16_f32 v104, v104, v105
    v_cvt_pk_bf16_f32 v105, v106, v107
    ds_write_b64 v20, v[104:105] offset:0
    s_waitcnt lgkmcnt(4)
    v_pk_add_f32 v[108:109], v[108:109], v[28:29]
    v_pk_add_f32 v[110:111], v[110:111], v[30:31]
    v_cvt_pk_bf16_f32 v108, v108, v109
    v_cvt_pk_bf16_f32 v109, v110, v111
    ds_write_b64 v20, v[108:109] offset:32
    s_waitcnt lgkmcnt(4)
    v_pk_add_f32 v[112:113], v[112:113], v[32:33]
    v_pk_add_f32 v[114:115], v[114:115], v[34:35]
    v_cvt_pk_bf16_f32 v112, v112, v113
    v_cvt_pk_bf16_f32 v113, v114, v115
    ds_write_b64 v20, v[112:113] offset:64
    s_waitcnt lgkmcnt(4)
    v_pk_add_f32 v[116:117], v[116:117], v[36:37]
    v_pk_add_f32 v[118:119], v[118:119], v[38:39]
    v_cvt_pk_bf16_f32 v116, v116, v117
    v_cvt_pk_bf16_f32 v117, v118, v119
    ds_write_b64 v20, v[116:117] offset:96
    s_waitcnt lgkmcnt(4)
    v_pk_add_f32 v[120:121], v[120:121], v[40:41]
    v_pk_add_f32 v[122:123], v[122:123], v[42:43]
    v_cvt_pk_bf16_f32 v120, v120, v121
    v_cvt_pk_bf16_f32 v121, v122, v123
    ds_write_b64 v20, v[120:121] offset:128
    s_waitcnt lgkmcnt(0)
    ds_read_b128 v[60:63], v50
    ds_read_b128 v[64:67], v51
    s_mov_b32 exec_hi, 0
    ds_read_b128 v[68:71], v52
    s_mov_b32 exec_hi, -1
    s_waitcnt lgkmcnt(2)
    buffer_store_dwordx4 v[60:63], v53, s[16:19], s33 offen nt
    s_waitcnt lgkmcnt(1)
    buffer_store_dwordx4 v[64:67], v54, s[16:19], s33 offen nt
    s_waitcnt lgkmcnt(0)
    s_mov_b32 exec_hi, 0
    buffer_store_dwordx4 v[68:71], v55, s[16:19], s33 offen nt
    s_mov_b32 exec_hi, -1
    s_branch L_fin
L_maskA:
    s_barrier
    v_add_u32 v20, 18, v20
    s_mov_b32 s36, 0x5555
    s_mov_b32 s37, 0
    v_lshlrev_b64 v[4:5], v20, s[36:37]
    v_not_b32 v4, v4
    v_not_b32 v5, v5
    v_bfe_i32 v36, v5, 0, 1
    v_bfe_i32 v52, v4, 0, 1
    v_and_b32 v36, v23, v36
    v_and_b32 v52, v23, v52
    v_bfe_i32 v37, v5, 1, 1
    v_bfe_i32 v53, v4, 1, 1
    v_and_b32 v37, v23, v37
    v_and_b32 v53, v23, v53
    v_bfe_i32 v38, v5, 2, 1
    v_bfe_i32 v54, v4, 2, 1
    v_and_b32 v38, v23, v38
    v_and_b32 v54, v23, v54
    v_bfe_i32 v39, v5, 3, 1
    v_bfe_i32 v55, v4, 3, 1
    v_and_b32 v39, v23, v39
    v_and_b32 v55, v23, v55
    v_bfe_i32 v40, v5, 8, 1
    v_bfe_i32 v56, v4, 8, 1
    v_and_b32 v40, v23, v40
    v_and_b32 v56, v23, v56
    v_bfe_i32 v41, v5, 9, 1
    v_bfe_i32 v57, v4, 9, 1
    v_and_b32 v41, v23, v41
    v_and_b32 v57, v23, v57
    v_bfe_i32 v42, v5, 10, 1
    v_bfe_i32 v58, v4, 10, 1
    v_and_b32 v42, v23, v42
    v_and_b32 v58, v23, v58
    v_bfe_i32 v43, v5, 11, 1
    v_bfe_i32 v59, v4, 11, 1
    v_and_b32 v43, v23, v43
    v_and_b32 v59, v23, v59
    v_bfe_i32 v44, v5, 16, 1
    v_bfe_i32 v60, v4, 16, 1
    v_and_b32 v44, v23, v44
    v_and_b32 v60, v23, v60
    v_bfe_i32 v45, v5, 17, 1
    v_bfe_i32 v61, v4, 17, 1
    v_and_b32 v45, v23, v45
    v_and_b32 v61, v23, v61
    v_bfe_i32 v46, v5, 18, 1
    v_bfe_i32 v62, v4, 18, 1
    v_and_b32 v46, v23, v46
    v_and_b32 v62, v23, v62
    v_bfe_i32 v47, v5, 19, 1
    v_bfe_i32 v63, v4, 19, 1
    v_and_b32 v47, v23, v47
    v_and_b32 v63, v23, v63
    v_bfe_i32 v48, v5, 24, 1
    v_bfe_i32 v64, v4, 24, 1
    v_and_b32 v48, v23, v48
    v_and_b32 v64, v23, v64
    v_bfe_i32 v49, v5, 25, 1
    v_bfe_i32 v65, v4, 25, 1
    v_and_b32 v49, v23, v49
    v_and_b32 v65, v23, v65
    v_bfe_i32 v50, v5, 26, 1
    v_bfe_i32 v66, v4, 26, 1
    v_and_b32 v50, v23, v50
    v_and_b32 v66, v23, v66
    v_bfe_i32 v51, v5, 27, 1
    v_bfe_i32 v67, v4, 27, 1
    v_and_b32 v51, v23, v51
    v_and_b32 v67, v23, v67
    s_branch L_mask_done
L_fallback:
    s_lshl_b32 s33, s29, 3
    s_add_u32 s33, s33, s50
    s_min_u32 s58, s33, 7
    s_cmp_eq_u32 s28, 0
    s_cselect_b32 s58, 0, s58
    s_cselect_b32 s34, 1, 8
    s_cmp_ge_u32 s33, s34
    s_cselect_b32 s55, 1, 0
    v_cmp_gt_u32 vcc, 32, v1
    s_nop 1
    v_cndmask_b32 v28, 0, v28, vcc
    v_cndmask_b32 v29, 0, v29, vcc
    v_mov_b32 v4, 0xf149f2ca
    v_mov_b32 v100, 0
    v_mov_b32 v101, 0
    v_mov_b32 v102, 0
    v_mov_b32 v103, 0
    v_mov_b32 v104, 0
    v_mov_b32 v105, 0
    v_mov_b32 v106, 0
    v_mov_b32 v107, 0
    v_mov_b32 v108, 0
    v_mov_b32 v109, 0
    v_mov_b32 v110, 0
    v_mov_b32 v111, 0
    v_mov_b32 v112, 0
    v_mov_b32 v113, 0
    v_mov_b32 v114, 0
    v_mov_b32 v115, 0
    v_cndmask_b32 v34, 0, v34, vcc
    v_cndmask_b32 v35, 0, v35, vcc
    v_mov_b32 v5, 0xf149f2ca
    v_mov_b32 v116, 0
    v_mov_b32 v117, 0
    v_mov_b32 v118, 0
    v_mov_b32 v119, 0
    v_mov_b32 v120, 0
    v_mov_b32 v121, 0
    v_mov_b32 v122, 0
    v_mov_b32 v123, 0
    v_mov_b32 v124, 0
    v_mov_b32 v125, 0
    v_mov_b32 v126, 0
    v_mov_b32 v127, 0
    v_mov_b32 v128, 0
    v_mov_b32 v129, 0
    v_mov_b32 v130, 0
    v_mov_b32 v131, 0
    v_sub_u32 v23, v10, v6
    v_add_u32 v6, v6, v23
    v_add_u32 v7, v7, v23
    v_add_u32 v8, v8, v23
    ds_read_b128 v[132:135], v6 offset:0
    ds_read_b64 v[136:137], v7 offset:32
    ds_read_b128 v[138:141], v6 offset:53248
    ds_read_b64 v[142:143], v7 offset:53280
    v_subrev_u32 v6, 3328, v6
    v_subrev_u32 v7, 3328, v7
    v_subrev_u32 v8, 3328, v8
    s_waitcnt lgkmcnt(0)
    v_mfma_f32_32x32x16_bf16 v[68:83], v[132:135], v[24:27], v[36:51]
    v_mfma_f32_32x32x8_bf16 v[68:83], v[136:137], v[28:29], v[68:83]
    v_mfma_f32_32x32x16_bf16 v[84:99], v[138:141], v[30:33], v[36:51]
    v_mfma_f32_32x32x8_bf16 v[84:99], v[142:143], v[34:35], v[84:99]
    s_nop 7
    s_nop 3
    v_max3_f32 v4, v68, v69, v4
    v_max3_f32 v4, v70, v71, v4
    v_max3_f32 v4, v72, v73, v4
    v_max3_f32 v4, v74, v75, v4
    v_max3_f32 v4, v76, v77, v4
    v_max3_f32 v4, v78, v79, v4
    v_max3_f32 v4, v80, v81, v4
    v_max3_f32 v4, v82, v83, v4
    v_max3_f32 v5, v84, v85, v5
    v_max3_f32 v5, v86, v87, v5
    v_max3_f32 v5, v88, v89, v5
    v_max3_f32 v5, v90, v91, v5
    v_max3_f32 v5, v92, v93, v5
    v_max3_f32 v5, v94, v95, v5
    v_max3_f32 v5, v96, v97, v5
    v_max3_f32 v5, v98, v99, v5
    s_mov_b32 s59, s58
    s_cmp_eq_u32 s59, 0
    s_cbranch_scc1 L_f1_f
L_f1_mid:
    ds_read_b128 v[132:135], v6 offset:0
    ds_read_b64 v[136:137], v7 offset:32
    ds_read_b128 v[138:141], v6 offset:53248
    ds_read_b64 v[142:143], v7 offset:53280
    v_subrev_u32 v6, 3328, v6
    v_subrev_u32 v7, 3328, v7
    v_subrev_u32 v8, 3328, v8
    s_waitcnt lgkmcnt(0)
    v_mfma_f32_32x32x16_bf16 v[68:83], v[132:135], v[24:27], 0
    v_mfma_f32_32x32x8_bf16 v[68:83], v[136:137], v[28:29], v[68:83]
    v_mfma_f32_32x32x16_bf16 v[84:99], v[138:141], v[30:33], 0
    v_mfma_f32_32x32x8_bf16 v[84:99], v[142:143], v[34:35], v[84:99]
    s_nop 7
    s_nop 3
    v_max3_f32 v4, v68, v69, v4
    v_max3_f32 v4, v70, v71, v4
    v_max3_f32 v4, v72, v73, v4
    v_max3_f32 v4, v74, v75, v4
    v_max3_f32 v4, v76, v77, v4
    v_max3_f32 v4, v78, v79, v4
    v_max3_f32 v4, v80, v81, v4
    v_max3_f32 v4, v82, v83, v4
    v_max3_f32 v5, v84, v85, v5
    v_max3_f32 v5, v86, v87, v5
    v_max3_f32 v5, v88, v89, v5
    v_max3_f32 v5, v90, v91, v5
    v_max3_f32 v5, v92, v93, v5
    v_max3_f32 v5, v94, v95, v5
    v_max3_f32 v5, v96, v97, v5
    v_max3_f32 v5, v98, v99, v5
    s_sub_u32 s59, s59, 1
    s_cmp_lg_u32 s59, 0
    s_cbranch_scc1 L_f1_mid
L_f1_f:
    s_cmp_eq_u32 s55, 0
    s_cbranch_scc1 L_f1_done
    ds_read_b128 v[132:135], v6 offset:0
    ds_read_b64 v[136:137], v7 offset:32
    ds_read_b128 v[138:141], v6 offset:53248
    ds_read_b64 v[142:143], v7 offset:53280
    v_subrev_u32 v6, 3328, v6
    v_subrev_u32 v7, 3328, v7
    v_subrev_u32 v8, 3328, v8
    s_waitcnt lgkmcnt(0)
    v_mfma_f32_32x32x16_bf16 v[68:83], v[132:135], v[24:27], v[52:67]
    v_mfma_f32_32x32x8_bf16 v[68:83], v[136:137], v[28:29], v[68:83]
    v_mfma_f32_32x32x16_bf16 v[84:99], v[138:141], v[30:33], v[52:67]
    v_mfma_f32_32x32x8_bf16 v[84:99], v[142:143], v[34:35], v[84:99]
    s_nop 7
    s_nop 3
    v_max3_f32 v4, v68, v69, v4
    v_max3_f32 v4, v70, v71, v4
    v_max3_f32 v4, v72, v73, v4
    v_max3_f32 v4, v74, v75, v4
    v_max3_f32 v4, v76, v77, v4
    v_max3_f32 v4, v78, v79, v4
    v_max3_f32 v4, v80, v81, v4
    v_max3_f32 v4, v82, v83, v4
    v_max3_f32 v5, v84, v85, v5
    v_max3_f32 v5, v86, v87, v5
    v_max3_f32 v5, v88, v89, v5
    v_max3_f32 v5, v90, v91, v5
    v_max3_f32 v5, v92, v93, v5
    v_max3_f32 v5, v94, v95, v5
    v_max3_f32 v5, v96, v97, v5
    v_max3_f32 v5, v98, v99, v5
L_f1_done:
    v_sub_u32 v23, v10, v6
    v_add_u32 v6, v6, v23
    v_add_u32 v7, v7, v23
    v_add_u32 v8, v8, v23
    v_cmp_gt_u32 vcc, 32, v1
    s_mov_b32 s33, 0xffff0000
    v_mov_b32 v20, v4
    s_nop 1
    v_permlane32_swap_b32 v20, v4
    v_max_f32 v20, v20, v4
    v_sub_f32 v20, 0, v20
    v_and_b32 v21, s33, v20
    v_sub_f32 v20, v20, v21
    v_and_b32 v22, s33, v20
    v_sub_f32 v20, v20, v22
    v_lshrrev_b32 v21, 16, v21
    v_or_b32 v21, v21, v22
    v_lshrrev_b32 v20, 16, v20
    v_cndmask_b32 v28, v21, v28, vcc
    v_cndmask_b32 v29, v20, v29, vcc
    v_mov_b32 v20, v5
    s_nop 1
    v_permlane32_swap_b32 v20, v5
    v_max_f32 v20, v20, v5
    v_sub_f32 v20, 0, v20
    v_and_b32 v21, s33, v20
    v_sub_f32 v20, v20, v21
    v_and_b32 v22, s33, v20
    v_sub_f32 v20, v20, v22
    v_lshrrev_b32 v21, 16, v21
    v_or_b32 v21, v21, v22
    v_lshrrev_b32 v20, 16, v20
    v_cndmask_b32 v34, v21, v34, vcc
    v_cndmask_b32 v35, v20, v35, vcc
    ds_read_b128 v[132:135], v6 offset:0
    ds_read_b64 v[136:137], v7 offset:32
    ds_read_b128 v[138:141], v6 offset:53248
    ds_read_b64 v[142:143], v7 offset:53280
    ds_read_b128 a[0:3], v8 offset:1536
    ds_read_b128 a[4:7], v8 offset:1568
    ds_read_b128 a[8:11], v8 offset:54784
    ds_read_b128 a[12:15], v8 offset:54816
    v_subrev_u32 v6, 3328, v6
    v_subrev_u32 v7, 3328, v7
    v_subrev_u32 v8, 3328, v8
    s_waitcnt lgkmcnt(6)
    v_mfma_f32_32x32x16_bf16 v[68:83], v[132:135], v[24:27], v[36:51]
    v_mfma_f32_32x32x8_bf16 v[68:83], v[136:137], v[28:29], v[68:83]
    s_waitcnt lgkmcnt(4)
    v_mfma_f32_32x32x16_bf16 v[84:99], v[138:141], v[30:33], v[36:51]
    v_mfma_f32_32x32x8_bf16 v[84:99], v[142:143], v[34:35], v[84:99]
    s_nop 7
    s_nop 3
    v_exp_f32 v68, v68
    v_exp_f32 v69, v69
    v_exp_f32 v70, v70
    v_exp_f32 v71, v71
    v_exp_f32 v72, v72
    v_exp_f32 v73, v73
    v_exp_f32 v74, v74
    v_exp_f32 v75, v75
    v_exp_f32 v76, v76
    v_exp_f32 v77, v77
    v_cvt_pk_bf16_f32 v144, v68, v69
    v_cvt_pk_bf16_f32 v145, v70, v71
    v_cvt_pk_bf16_f32 v146, v72, v73
    v_cvt_pk_bf16_f32 v147, v74, v75
    v_exp_f32 v78, v78
    v_exp_f32 v79, v79
    v_exp_f32 v80, v80
    v_exp_f32 v81, v81
    v_exp_f32 v82, v82
    v_exp_f32 v83, v83
    v_cvt_pk_bf16_f32 v148, v76, v77
    v_cvt_pk_bf16_f32 v149, v78, v79
    v_cvt_pk_bf16_f32 v150, v80, v81
    v_cvt_pk_bf16_f32 v151, v82, v83
    s_waitcnt lgkmcnt(0)
    v_mfma_f32_32x32x16_bf16 v[100:115], a[0:3], v[144:147], v[100:115]
    v_exp_f32 v84, v84
    v_exp_f32 v85, v85
    v_exp_f32 v86, v86
    v_exp_f32 v87, v87
    v_mfma_f32_32x32x16_bf16 v[100:115], a[4:7], v[148:151], v[100:115]
    v_exp_f32 v88, v88
    v_exp_f32 v89, v89
    v_exp_f32 v90, v90
    v_exp_f32 v91, v91
    v_exp_f32 v92, v92
    v_exp_f32 v93, v93
    v_cvt_pk_bf16_f32 v152, v84, v85
    v_cvt_pk_bf16_f32 v153, v86, v87
    v_cvt_pk_bf16_f32 v154, v88, v89
    v_cvt_pk_bf16_f32 v155, v90, v91
    v_exp_f32 v94, v94
    v_exp_f32 v95, v95
    v_exp_f32 v96, v96
    v_exp_f32 v97, v97
    v_exp_f32 v98, v98
    v_exp_f32 v99, v99
    v_cvt_pk_bf16_f32 v156, v92, v93
    v_cvt_pk_bf16_f32 v157, v94, v95
    v_cvt_pk_bf16_f32 v158, v96, v97
    v_cvt_pk_bf16_f32 v159, v98, v99
    v_mfma_f32_32x32x16_bf16 v[116:131], a[8:11], v[152:155], v[116:131]
    s_nop 0
    v_mfma_f32_32x32x16_bf16 v[116:131], a[12:15], v[156:159], v[116:131]
    s_nop 7
    s_mov_b32 s59, s58
    s_cmp_eq_u32 s59, 0
    s_cbranch_scc1 L_f2_f
L_f2_mid:
    ds_read_b128 v[132:135], v6 offset:0
    ds_read_b64 v[136:137], v7 offset:32
    ds_read_b128 v[138:141], v6 offset:53248
    ds_read_b64 v[142:143], v7 offset:53280
    ds_read_b128 a[0:3], v8 offset:1536
    ds_read_b128 a[4:7], v8 offset:1568
    ds_read_b128 a[8:11], v8 offset:54784
    ds_read_b128 a[12:15], v8 offset:54816
    v_subrev_u32 v6, 3328, v6
    v_subrev_u32 v7, 3328, v7
    v_subrev_u32 v8, 3328, v8
    s_waitcnt lgkmcnt(6)
    v_mfma_f32_32x32x16_bf16 v[68:83], v[132:135], v[24:27], 0
    v_mfma_f32_32x32x8_bf16 v[68:83], v[136:137], v[28:29], v[68:83]
    s_waitcnt lgkmcnt(4)
    v_mfma_f32_32x32x16_bf16 v[84:99], v[138:141], v[30:33], 0
    v_mfma_f32_32x32x8_bf16 v[84:99], v[142:143], v[34:35], v[84:99]
    s_nop 7
    s_nop 3
    v_exp_f32 v68, v68
    v_exp_f32 v69, v69
    v_exp_f32 v70, v70
    v_exp_f32 v71, v71
    v_exp_f32 v72, v72
    v_exp_f32 v73, v73
    v_exp_f32 v74, v74
    v_exp_f32 v75, v75
    v_exp_f32 v76, v76
    v_exp_f32 v77, v77
    v_cvt_pk_bf16_f32 v144, v68, v69
    v_cvt_pk_bf16_f32 v145, v70, v71
    v_cvt_pk_bf16_f32 v146, v72, v73
    v_cvt_pk_bf16_f32 v147, v74, v75
    v_exp_f32 v78, v78
    v_exp_f32 v79, v79
    v_exp_f32 v80, v80
    v_exp_f32 v81, v81
    v_exp_f32 v82, v82
    v_exp_f32 v83, v83
    v_cvt_pk_bf16_f32 v148, v76, v77
    v_cvt_pk_bf16_f32 v149, v78, v79
    v_cvt_pk_bf16_f32 v150, v80, v81
    v_cvt_pk_bf16_f32 v151, v82, v83
    s_waitcnt lgkmcnt(0)
    v_mfma_f32_32x32x16_bf16 v[100:115], a[0:3], v[144:147], v[100:115]
    v_exp_f32 v84, v84
    v_exp_f32 v85, v85
    v_exp_f32 v86, v86
    v_exp_f32 v87, v87
    v_mfma_f32_32x32x16_bf16 v[100:115], a[4:7], v[148:151], v[100:115]
    v_exp_f32 v88, v88
    v_exp_f32 v89, v89
    v_exp_f32 v90, v90
    v_exp_f32 v91, v91
    v_exp_f32 v92, v92
    v_exp_f32 v93, v93
    v_cvt_pk_bf16_f32 v152, v84, v85
    v_cvt_pk_bf16_f32 v153, v86, v87
    v_cvt_pk_bf16_f32 v154, v88, v89
    v_cvt_pk_bf16_f32 v155, v90, v91
    v_exp_f32 v94, v94
    v_exp_f32 v95, v95
    v_exp_f32 v96, v96
    v_exp_f32 v97, v97
    v_exp_f32 v98, v98
    v_exp_f32 v99, v99
    v_cvt_pk_bf16_f32 v156, v92, v93
    v_cvt_pk_bf16_f32 v157, v94, v95
    v_cvt_pk_bf16_f32 v158, v96, v97
    v_cvt_pk_bf16_f32 v159, v98, v99
    v_mfma_f32_32x32x16_bf16 v[116:131], a[8:11], v[152:155], v[116:131]
    s_nop 0
    v_mfma_f32_32x32x16_bf16 v[116:131], a[12:15], v[156:159], v[116:131]
    s_nop 7
    s_sub_u32 s59, s59, 1
    s_cmp_lg_u32 s59, 0
    s_cbranch_scc1 L_f2_mid
L_f2_f:
    s_cmp_eq_u32 s55, 0
    s_cbranch_scc1 L_f2_done
    ds_read_b128 v[132:135], v6 offset:0
    ds_read_b64 v[136:137], v7 offset:32
    ds_read_b128 v[138:141], v6 offset:53248
    ds_read_b64 v[142:143], v7 offset:53280
    ds_read_b128 a[0:3], v8 offset:1536
    ds_read_b128 a[4:7], v8 offset:1568
    ds_read_b128 a[8:11], v8 offset:54784
    ds_read_b128 a[12:15], v8 offset:54816
    v_subrev_u32 v6, 3328, v6
    v_subrev_u32 v7, 3328, v7
    v_subrev_u32 v8, 3328, v8
    s_waitcnt lgkmcnt(6)
    v_mfma_f32_32x32x16_bf16 v[68:83], v[132:135], v[24:27], v[52:67]
    v_mfma_f32_32x32x8_bf16 v[68:83], v[136:137], v[28:29], v[68:83]
    s_waitcnt lgkmcnt(4)
    v_mfma_f32_32x32x16_bf16 v[84:99], v[138:141], v[30:33], v[52:67]
    v_mfma_f32_32x32x8_bf16 v[84:99], v[142:143], v[34:35], v[84:99]
    s_nop 7
    s_nop 3
    v_exp_f32 v68, v68
    v_exp_f32 v69, v69
    v_exp_f32 v70, v70
    v_exp_f32 v71, v71
    v_exp_f32 v72, v72
    v_exp_f32 v73, v73
    v_exp_f32 v74, v74
    v_exp_f32 v75, v75
    v_exp_f32 v76, v76
    v_exp_f32 v77, v77
    v_cvt_pk_bf16_f32 v144, v68, v69
    v_cvt_pk_bf16_f32 v145, v70, v71
    v_cvt_pk_bf16_f32 v146, v72, v73
    v_cvt_pk_bf16_f32 v147, v74, v75
    v_exp_f32 v78, v78
    v_exp_f32 v79, v79
    v_exp_f32 v80, v80
    v_exp_f32 v81, v81
    v_exp_f32 v82, v82
    v_exp_f32 v83, v83
    v_cvt_pk_bf16_f32 v148, v76, v77
    v_cvt_pk_bf16_f32 v149, v78, v79
    v_cvt_pk_bf16_f32 v150, v80, v81
    v_cvt_pk_bf16_f32 v151, v82, v83
    s_waitcnt lgkmcnt(0)
    v_mfma_f32_32x32x16_bf16 v[100:115], a[0:3], v[144:147], v[100:115]
    v_exp_f32 v84, v84
    v_exp_f32 v85, v85
    v_exp_f32 v86, v86
    v_exp_f32 v87, v87
    v_mfma_f32_32x32x16_bf16 v[100:115], a[4:7], v[148:151], v[100:115]
    v_exp_f32 v88, v88
    v_exp_f32 v89, v89
    v_exp_f32 v90, v90
    v_exp_f32 v91, v91
    v_exp_f32 v92, v92
    v_exp_f32 v93, v93
    v_cvt_pk_bf16_f32 v152, v84, v85
    v_cvt_pk_bf16_f32 v153, v86, v87
    v_cvt_pk_bf16_f32 v154, v88, v89
    v_cvt_pk_bf16_f32 v155, v90, v91
    v_exp_f32 v94, v94
    v_exp_f32 v95, v95
    v_exp_f32 v96, v96
    v_exp_f32 v97, v97
    v_exp_f32 v98, v98
    v_exp_f32 v99, v99
    v_cvt_pk_bf16_f32 v156, v92, v93
    v_cvt_pk_bf16_f32 v157, v94, v95
    v_cvt_pk_bf16_f32 v158, v96, v97
    v_cvt_pk_bf16_f32 v159, v98, v99
    v_mfma_f32_32x32x16_bf16 v[116:131], a[8:11], v[152:155], v[116:131]
    s_nop 0
    v_mfma_f32_32x32x16_bf16 v[116:131], a[12:15], v[156:159], v[116:131]
    s_nop 7
L_f2_done:
    s_nop 7
    s_nop 3
    s_branch L_fb_ret
L_fin:
L_end:
    s_endpgm
.section .rodata,"a"
.p2align 6
.amdhsa_kernel concat_heads__sliding_local_dilated__sliding_block__prompt_kernel
  .amdhsa_next_free_vgpr 256
  .amdhsa_next_free_sgpr 102
  .amdhsa_accum_offset 160
  .amdhsa_group_segment_fixed_size 0
  .amdhsa_kernarg_size 72
  .amdhsa_user_sgpr_count 2
  .amdhsa_user_sgpr_kernarg_segment_ptr 1
  .amdhsa_system_sgpr_workgroup_id_x 1
.end_amdhsa_kernel
```
